```python
import torch

def _softmax(x, axis=-1):
    return torch.softmax(x, dim=axis)
def _gelu(x):
    return torch.nn.functional.gelu(x, approximate="tanh")
def _silu(x):
    return torch.nn.functional.silu(x)
def _sigmoid(x):
    return torch.sigmoid(x)
def _layernorm(x, axis=-1, eps=1e-5):
    m = x.mean(dim=axis, keepdim=True)
    v = x.var(dim=axis, keepdim=True, unbiased=False)
    return (x - m) / torch.sqrt(v + eps)
def _scatter_add(tgt, idx, src, axis=0):
    return tgt.clone().index_add_(axis, idx, src)
def _segment_sum(src, seg, n):
    out = torch.zeros((n,) + src.shape[1:], dtype=src.dtype)
    return out.index_add_(0, seg, src)
def _pad(x, pw):
    flat = tuple(v for pair in reversed(pw) for v in pair)
    return torch.nn.functional.pad(x, flat)

kernel_name = 'concat_heads__ssm_conv_h3__spectral_fnet__prompt'

def setup_inputs():

    _w = (lambda a: (lambda t: t.to(torch.bfloat16) if t.is_floating_point() else t)(torch.as_tensor(a)))
    def _A_setup():
        B, S, D = 1, 2048, 576
        ks = 4
        return {
            "q": _w((lambda *s: torch.randn(*s, dtype=torch.bfloat16) * 0.05)(B, S, D)),
            "k": _w((lambda *s: torch.randn(*s, dtype=torch.bfloat16) * 3.2)(B, S, D)),
            "v": _w((lambda *s: torch.randn(*s, dtype=torch.bfloat16) * 3.2)(B, S, D)),
            "shift_k": _w((lambda *s: torch.randn(*s, dtype=torch.bfloat16) * 3.2)(D, ks) * 0.5),
            "ssm_k": _w((lambda *s: torch.randn(*s, dtype=torch.bfloat16) * 3.2)(D, S) * (1.0 / S ** 0.5)),
            "ssm_D": _w((lambda *s: torch.randn(*s, dtype=torch.bfloat16) * 3.2)(D)),
        }
    _A_in = _A_setup()

    def _B_setup():
        B, S, D = 1, 2048, 576
        ns = torch.arange(S)[:, None] * torch.arange(S)[None, :]
        nd = torch.arange(D)[:, None] * torch.arange(D)[None, :]
        Ws_re = torch.cos(-2.0 * torch.pi * ns / S).to(float)
        Ws_im = torch.sin(-2.0 * torch.pi * ns / S).to(float)
        Wd_re = torch.cos(-2.0 * torch.pi * nd / D).to(float)
        Wd_im = torch.sin(-2.0 * torch.pi * nd / D).to(float)
        return {
            "x": _w((lambda *s: torch.randn(*s, dtype=torch.bfloat16) * 0.05)(B, S, D)),
            "dft_seq_re": _w(Ws_re),
            "dft_seq_im": _w(Ws_im),
            "dft_hid_re": _w(Wd_re),
            "dft_hid_im": _w(Wd_im),
        }
    _B_in = _B_setup()

    return {
        "A_q": _A_in["q"],
        "A_k": _A_in["k"],
        "A_v": _A_in["v"],
        "A_shift_k": _A_in["shift_k"],
        "A_ssm_k": _A_in["ssm_k"],
        "A_ssm_D": _A_in["ssm_D"],
        "B_x": _B_in["x"],
        "B_dft_seq_re": _B_in["dft_seq_re"],
        "B_dft_seq_im": _B_in["dft_seq_im"],
        "B_dft_hid_re": _B_in["dft_hid_re"],
        "B_dft_hid_im": _B_in["dft_hid_im"],
    }

def reference(A_q, A_k, A_v, A_shift_k, A_ssm_k, A_ssm_D, B_x, B_dft_seq_re, B_dft_seq_im, B_dft_hid_re, B_dft_hid_im):
    def _A_ref(q, k, v, shift_k, ssm_k, ssm_D):
        B, S, D = q.shape
        ks = shift_k.shape[-1]
        k_pad = _pad(k, ((0, 0), (ks - 1, 0), (0, 0)))
        k_shift = torch.zeros_like(k)
        for t in range(ks):
            k_shift = k_shift + k_pad[:, t:t + S, :] * shift_k[:, ks - 1 - t][None, None, :]
        kv = k_shift * v
        L = 2 * S
        kv_pad = _pad(kv, ((0, 0), (0, S), (0, 0)))
        kf_pad = _pad(ssm_k, ((0, 0), (0, S)))
        kv_f = (lambda x, axes=(-2,-1): torch.fft.rfft2(x.float(), dim=axes))(kv_pad[:, None, :, :], axes=(1, 2))
        kf_f = (lambda x, axes=(-2,-1): torch.fft.rfft2(x.float(), dim=axes))(kf_pad[:, None, :], axes=(1, 2))
        kf_f = (lambda x, *d: x.permute(*d))(kf_f, 1, 2, 0)
        y_f = kv_f * kf_f[None, :, :, :]
        y = (lambda x, s, axes=(-2,-1): torch.fft.irfft2(x, s=s, dim=axes).to(torch.bfloat16))(y_f, (1, L), axes=(1, 2))[:, 0, :S, :]
        y = y + kv * ssm_D[None, None, :]
        return q * y

    def _B_ref(x, dft_seq_re, dft_seq_im, dft_hid_re, dft_hid_im):
        a = torch.einsum("bsd,ed->bse", x, dft_hid_re)
        b = torch.einsum("bsd,ed->bse", x, dft_hid_im)
        y = torch.einsum("ts,bse->bte", dft_seq_re, a) - torch.einsum("ts,bse->bte", dft_seq_im, b)
        return y

    a = _A_ref(A_q, A_k, A_v, A_shift_k, A_ssm_k, A_ssm_D)
    b = _B_ref(B_x, B_dft_seq_re, B_dft_seq_im, B_dft_hid_re, B_dft_hid_im)
    return torch.concatenate([a, b], axis=-1)
```

```asm
; @launch grid=(256,1,1) block=(512,1,1) lds=151040
.amdgcn_target "amdgcn-amd-amdhsa--gfx950"
.text
.globl concat_heads__ssm_conv_h3__spectral_fnet__prompt_kernel
.p2align 8
.type concat_heads__ssm_conv_h3__spectral_fnet__prompt_kernel,@function
concat_heads__ssm_conv_h3__spectral_fnet__prompt_kernel:
    s_load_dwordx8 s[4:11], s[0:1], 0
    s_load_dwordx2 s[44:45], s[0:1], 48
    s_load_dwordx2 s[46:47], s[0:1], 104
    s_load_dwordx4 s[48:51], s[0:1], 32
    s_getpc_b64 s[56:57]
L_pc:
    s_lshr_b32 s60, s2, 3
    s_lshl_b32 s60, s60, 10
    s_add_u32 s58, s60, 1024
    s_min_u32 s58, s58, L_code_end-L_pc
    s_and_b32 s57, s57, 0xffff
    s_mov_b32 s59, 0x20000
    v_lshlrev_b32 v1, 7, v0
    buffer_load_dword v204, v1, s[56:59], s60 offen
    v_lshrrev_b32 v1, 6, v0
    v_and_b32 v2, 63, v0
    v_readfirstlane_b32 s28, v1
    s_cmp_ge_u32 s2, 256
    s_cbranch_scc1 L_exit0
    s_and_b32 s29, s2, 7
    s_and_b32 s31, s2, 0x78
    s_add_u32 s31, s31, s28
    s_mul_i32 s32, s31, 18432
    s_lshl_b32 s33, s29, 7
    s_add_u32 s32, s32, s33
    s_sub_u32 s32, s32, 4608
    s_sub_u32 s3, s2, 128
    s_lshl_b32 s33, s28, 8
    s_add_u32 s33, s33, s3
    s_mul_i32 s33, s33, 1152
    s_mul_i32 s34, s28, 7680
    s_add_u32 s34, s34, 20992
    s_mul_i32 s38, s28, 2304
    s_add_u32 s38, s38, 57984
    v_lshrrev_b32 v3, 3, v2
    v_and_b32 v4, 7, v2
    v_mul_u32_u24 v5, 1152, v3
    v_lshl_add_u32 v15, v4, 4, v5
    v_min_u32 v3, 1, v3
    v_lshlrev_b32 v6, 4, v2
    s_cmp_ge_u32 s2, 128
    s_cselect_b64 vcc, -1, 0
    s_cselect_b32 s32, s33, s32
    s_cselect_b32 s34, s38, s34
    s_cselect_b32 s36, 146304, 0
    s_cselect_b32 s37, 0, 8192
    s_cselect_b32 s38, 0xffff, -1
    s_movk_i32 s39, 16384
    s_cselect_b32 s39, 146304, s39
    v_mul_lo_u32 v4, v3, s36
    v_cndmask_b32 v3, v15, v6, vcc
    v_add_u32 v3, s32, v3
    v_add3_u32 v4, v4, v3, s37
    v_add_u32 v6, s39, v3
    s_mov_b32 s14, 2359296
    s_mov_b32 s15, 0x20000
    s_mov_b32 m0, s34
    s_waitcnt lgkmcnt(0)
    s_cselect_b32 s12, s44, s6
    s_cselect_b32 s13, s45, s7
    buffer_load_dwordx4 v3, s[12:15], 0 offen lds
    buffer_load_dwordx4 v4, s[12:15], 0 offen offset:1024 lds
    s_mov_b32 exec_hi, 0
    s_mov_b32 exec_lo, s38
    buffer_load_dwordx4 v6, s[12:15], 0 offen offset:2048 lds
    s_mov_b64 exec, -1
    s_cbranch_scc1 L_k1b
    s_mov_b32 s16, s8
    s_mov_b32 s18, 2359296
    s_mov_b32 s19, 0x20000
    s_mov_b32 s35, 9216
    v_add_u32 v5, 4608, v3
    s_add_u32 m0, s34, 3072
    s_and_b32 s17, s9, 0xffff
    buffer_load_dwordx4 v5, s[16:19], 0 offen lds
    s_add_u32 m0, s34, 4096
    v_lshlrev_b32 v6, 3, v2
    buffer_load_dwordx4 v5, s[16:19], s35 offen lds
    s_mov_b32 s24, s10
    s_and_b32 s25, s11, 0xffff
    s_mov_b32 s26, 4608
    s_mov_b32 s27, 0x20000
    s_lshl_b32 s33, s29, 9
    buffer_load_dwordx2 v[8:9], v6, s[24:27], s33 offen
    s_cmp_ge_u32 s28, 2
    s_cbranch_scc1 L_x1
    s_lshl_b32 s30, s2, 1
    s_add_u32 s30, s30, s28
    s_mul_i32 s32, s30, 9216
    s_sub_u32 s32, s32, 3584
    v_add_u32 v60, s32, v15
    v_add_u32 v61, 9216, v60
    s_add_u32 m0, s34, 5120
    v_add_u32 v62, 4608, v60
    buffer_load_dwordx4 v60, s[12:15], 0 offen lds
    s_add_u32 m0, s34, 6144
    s_mov_b32 exec_hi, 0
    buffer_load_dwordx4 v61, s[12:15], 0 offen lds
    s_add_u32 m0, s34, 6656
    s_mov_b32 exec_hi, -1
    buffer_load_dwordx4 v62, s[16:19], 0 offen lds
    s_movk_i32 s33, 4096
    buffer_load_dwordx2 v[64:65], v6, s[24:27], s33 offen
L_x1:
    s_branch L_k1a
L_exit0:
    s_endpgm
L_k1b:
    v_and_b32 v3, 31, v2
    v_lshrrev_b32 v4, 5, v2
    v_mul_u32_u24 v5, 7, v3
    v_mul_u32_u24 v6, 57, v5
    v_lshrrev_b32 v6, 9, v6
    v_mul_u32_u24 v6, 9, v6
    v_sub_u32 v5, v5, v6
    v_mul_u32_u24 v6, 1152, v4
    v_lshl_add_u32 v6, v3, 2, v6
    v_lshl_add_u32 v6, v5, 7, v6
    v_add_u32 v8, s34, v6
    v_subrev_u32 v7, 1152, v8
    v_cmp_le_u32 s[30:31], 8, v5
    v_cmp_le_u32 s[32:33], 7, v5
    v_cmp_le_u32 s[34:35], 6, v5
    v_cmp_le_u32 s[36:37], 5, v5
    v_cndmask_b32 v9, v8, v7, s[30:31]
    v_cndmask_b32 v10, v8, v7, s[32:33]
    v_cndmask_b32 v11, v8, v7, s[34:35]
    v_cndmask_b32 v12, v8, v7, s[36:37]
    v_cmp_le_u32 s[30:31], 4, v5
    v_cmp_le_u32 s[32:33], 3, v5
    v_cmp_le_u32 s[34:35], 2, v5
    v_cmp_le_u32 s[36:37], 1, v5
    v_cndmask_b32 v13, v8, v7, s[30:31]
    v_cndmask_b32 v14, v8, v7, s[32:33]
    v_cndmask_b32 v15, v8, v7, s[34:35]
    v_cndmask_b32 v16, v8, v7, s[36:37]
    s_add_u32 s56, s46, 5013504
    s_addc_u32 s57, s47, 0
    s_load_dword s63, s[56:57], 0
    s_and_b32 s57, s57, 0xffff
    s_mov_b32 s58, 53248
    s_mov_b32 s59, 0x20000
    v_mov_b32 v196, 0
    v_lshlrev_b32 v197, 2, v0
    ds_write_b32 v197, v196 offset:256
    ds_write_b32 v197, v196 offset:10496
    v_lshlrev_b32 v197, 2, v2
    ds_write_b32 v197, v196
    s_and_b32 s60, s3, 7
    s_lshr_b32 s61, s3, 3
    s_mul_i32 s44, s60, 9
    s_add_u32 s44, s44, s61
    s_sub_u32 s44, s44, 36
    s_mul_i32 s62, s61, 9
    s_sub_u32 s62, s62, 28
    s_cmp_eq_u32 s60, 2
    s_cselect_b32 s44, s62, s44
    s_cmp_eq_u32 s60, 3
    s_cselect_b32 s44, 99, s44
    s_mov_b32 s45, 2
    s_lshl_b32 s62, s60, 2
    s_add_u32 s62, s62, s61
    s_lshl_b32 s62, s62, 1
    s_add_u32 s62, s62, 112
    s_or_b32 s36, s60, s61
    s_cmp_lt_u32 s36, 4
    s_cselect_b32 s44, s62, s44
    s_cselect_b32 s45, 1, s45
    s_lshl_b32 s62, s60, 3
    s_add_u32 s62, s62, s61
    s_add_u32 s36, s62, 128
    s_cmp_lt_u32 s60, 2
    s_cselect_b32 s44, s36, s44
    s_cselect_b32 s45, 0, s45
    s_sub_u32 s62, s62, 8
    s_lshl_b32 s62, s62, 1
    s_cmp_ge_u32 s61, 8
    s_cselect_b32 s44, s62, s44
    s_cselect_b32 s45, 1, s45
    s_and_b32 s60, s28, 3
    s_lshr_b32 s61, s28, 2
    s_cmp_lg_u32 s45, 0
    s_cselect_b32 s60, s28, s60
    s_cselect_b32 s61, 0, s61
    s_lshl_b32 s62, s44, 2
    s_add_u32 s60, s60, s62
    s_lshr_b32 s62, s60, 1
    s_lshl_b32 s62, s62, 2
    s_load_dword s41, s[50:51], s62
    s_lshl_b32 s60, s60, 12
    s_add_u32 s62, s60, 2040
    s_load_dwordx2 s[54:55], s[48:49], s62
    s_lshl_b32 s61, s61, 11
    s_add_u32 s62, s60, s61
    s_cmp_lg_u32 s28, 7
    s_cbranch_scc1 L_b_nof
    s_lshl_b32 s37, s3, 7
    s_add_u32 s37, s37, 20480
    buffer_load_dword v201, off, s[56:59], s37 sc1
L_b_nof:
    s_and_b32 s31, s3, 7
    s_lshr_b32 s36, s3, 3
    s_cmp_lt_u32 s31, 2
    s_cselect_b32 s37, 16, 0
    s_add_u32 s37, s37, s36
    s_cmp_ge_u32 s31, 4
    s_cselect_b32 s37, 64, s37
    s_lshl_b32 s36, s36, 1
    s_and_b32 s39, s28, 1
    s_add_u32 s36, s36, s39
    s_cmp_ge_u32 s28, 4
    s_cselect_b32 s31, 8, s31
    s_cselect_b32 s36, s37, s36
    s_lshl_b32 s31, s31, 7
    s_mul_i32 s36, s36, 73728
    s_add_u32 s31, s31, s36
    v_mul_u32_u24 v202, 1152, v2
    s_mov_b32 s20, s4
    s_and_b32 s21, s5, 0xffff
    s_mov_b32 s22, 2359296
    s_mov_b32 s23, 0x20000
    s_add_u32 s10, s46, 2359296
    s_addc_u32 s11, s47, 0
    s_mov_b32 s16, s10
    s_and_b32 s17, s11, 0xffff
    s_mov_b32 s18, 2654208
    s_mov_b32 s19, 0x20000
    v_lshrrev_b32 v6, 2, v3
    v_xor_b32 v6, s28, v6
    v_lshlrev_b32 v6, 4, v6
    v_lshl_add_u32 v6, v4, 7, v6
    v_and_b32 v7, 3, v3
    v_lshl_add_u32 v6, v7, 2, v6
    s_lshl_b32 s39, s28, 8
    s_add_u32 s39, s39, 20992
    v_add_u32 v17, s39, v6
    v_and_b32 v3, 15, v2
    v_lshrrev_b32 v4, 4, v2
    v_lshrrev_b32 v6, 1, v3
    v_xor_b32 v6, v6, v4
    v_lshlrev_b32 v6, 4, v6
    v_lshl_add_u32 v6, v3, 7, v6
    v_add_u32 v18, 20992, v6
    v_xor_b32 v19, 64, v18
    s_and_b32 s39, s28, 3
    s_lshl_b32 s39, s39, 4
    v_add_u32 v5, s39, v3
    v_mul_u32_u24 v6, 9, v5
    v_mul_u32_u24 v7, 4640, v4
    v_add_u32 v7, 39424, v7
    s_mov_b32 s40, 0x80008000
    v_mov_b32 v33, s40
    s_lshr_b32 s30, s28, 2
    s_lshl_b32 s39, s30, 7
    s_add_u32 s39, s39, 64
    v_add_u32 v32, s39, v6
    v_subrev_u32 v34, 576, v32
    v_min_u32 v32, v32, v34
    v_sub_u32 v34, 576, v32
    v_cmp_lt_u32 vcc, v34, v32
    v_min_u32 v32, v32, v34
    v_lshl_add_u32 v20, v32, 4, v7
    v_cndmask_b32 v23, 0, v33, vcc
    s_add_u32 s39, s39, 64
    v_add_u32 v32, s39, v6
    v_subrev_u32 v34, 576, v32
    v_min_u32 v32, v32, v34
    v_sub_u32 v34, 576, v32
    v_cmp_lt_u32 vcc, v34, v32
    v_min_u32 v32, v32, v34
    v_lshl_add_u32 v21, v32, 4, v7
    v_cndmask_b32 v24, 0, v33, vcc
    v_sub_u32 v34, 576, v6
    v_cmp_lt_u32 vcc, v34, v6
    v_min_u32 v32, v6, v34
    v_lshl_add_u32 v22, v32, 4, v7
    v_cndmask_b32 v25, 0, v33, vcc
    s_lshl_b32 s39, s28, 2
    v_add_u32 v32, s39, v4
    v_and_b32 v34, 3, v2
    v_bfe_u32 v35, v2, 2, 2
    v_mul_u32_u24 v36, 4640, v34
    v_lshl_add_u32 v36, v35, 7, v36
    v_add_u32 v36, 39424, v36
    v_mul_u32_u24 v37, 663552, v35
    v_lshl_add_u32 v37, v34, 4, v37
    s_mul_i32 s42, s3, 576
    s_mov_b32 s43, 73152
    v_mul_u32_u24 v38, 57, v32
    v_lshrrev_b32 v38, 9, v38
    v_mad_u32_u24 v39, v38, 23, v32
    v_lshl_add_u32 v26, v39, 4, v36
    v_lshl_add_u32 v39, v32, 6, v37
    v_mad_u32_u24 v29, v38, s43, v39
    v_add_u32 v32, 28, v32
    v_mul_u32_u24 v38, 57, v32
    v_lshrrev_b32 v38, 9, v38
    v_mad_u32_u24 v39, v38, 23, v32
    v_lshl_add_u32 v27, v39, 4, v36
    v_lshl_add_u32 v39, v32, 6, v37
    v_mad_u32_u24 v30, v38, s43, v39
    v_add_u32 v32, 28, v32
    v_cmp_lt_u32 vcc, 80, v32
    v_min_u32 v32, 80, v32
    v_mul_u32_u24 v38, 57, v32
    v_lshrrev_b32 v38, 9, v38
    v_mad_u32_u24 v39, v38, 23, v32
    v_lshl_add_u32 v28, v39, 4, v36
    v_lshl_add_u32 v39, v32, 6, v37
    v_mad_u32_u24 v31, v38, s43, v39
    v_cndmask_b32 v31, v31, v33, vcc
    v_and_b32 v82, 255, v0
    v_lshlrev_b32 v82, 4, v82
    v_add_u32 v82, 82432, v82
    s_cmp_lg_u32 s30, 0
    s_cbranch_scc1 L_b_seqc
    v_cvt_f32_u32 v72, v5
    v_mul_f32 v72, 0x3c800000, v72
    v_lshlrev_b32 v73, 3, v4
    v_cvt_f32_u32 v73, v73
    v_mul_f32 v74, v73, v72
    v_add_f32 v75, v74, v72
    v_add_f32 v73, v72, v72
    v_and_b32 v76, 1, v5
    v_mul_lo_u32 v76, v76, v33
    v_xor_b32 v77, s40, v76
    v_cos_f32 v78, v74
    v_cos_f32 v79, v75
    v_sin_f32 v80, v74
    v_sin_f32 v81, v75
    v_add_f32 v74, v74, v73
    v_add_f32 v75, v75, v73
    v_cvt_pk_bf16_f32 v40, v78, v79
    v_cvt_pk_bf16_f32 v48, v80, v81
    v_xor_b32 v44, v76, v40
    v_xor_b32 v56, s40, v48
    v_xor_b32 v52, v76, v48
    v_xor_b32 v60, v77, v48
    v_cos_f32 v78, v74
    v_cos_f32 v79, v75
    v_sin_f32 v80, v74
    v_sin_f32 v81, v75
    v_add_f32 v74, v74, v73
    v_add_f32 v75, v75, v73
    v_cvt_pk_bf16_f32 v41, v78, v79
    v_cvt_pk_bf16_f32 v49, v80, v81
    v_xor_b32 v45, v76, v41
    v_xor_b32 v57, s40, v49
    v_xor_b32 v53, v76, v49
    v_xor_b32 v61, v77, v49
    v_cos_f32 v78, v74
    v_cos_f32 v79, v75
    v_sin_f32 v80, v74
    v_sin_f32 v81, v75
    v_add_f32 v74, v74, v73
    v_add_f32 v75, v75, v73
    v_cvt_pk_bf16_f32 v42, v78, v79
    v_cvt_pk_bf16_f32 v50, v80, v81
    v_xor_b32 v46, v76, v42
    v_xor_b32 v58, s40, v50
    v_xor_b32 v54, v76, v50
    v_xor_b32 v62, v77, v50
    v_cos_f32 v78, v74
    v_cos_f32 v79, v75
    v_sin_f32 v80, v74
    v_sin_f32 v81, v75
    v_cvt_pk_bf16_f32 v43, v78, v79
    v_cvt_pk_bf16_f32 v51, v80, v81
    v_xor_b32 v47, v76, v43
    v_xor_b32 v59, s40, v51
    v_xor_b32 v55, v76, v51
    v_xor_b32 v63, v77, v51
    ds_write_b128 v82, v[40:43] offset:0
    ds_write_b128 v82, v[44:47] offset:4096
    ds_write_b128 v82, v[48:51] offset:8192
    ds_write_b128 v82, v[52:55] offset:12288
    ds_write_b128 v82, v[56:59] offset:16384
    ds_write_b128 v82, v[60:63] offset:20480
    s_branch L_b_cdone
L_b_seqc:
    v_cvt_f32_u32 v72, v3
    v_cvt_f32_u32 v73, s3
    v_add_f32 v74, 0xc1000000, v72
    v_mul_f32 v73, v73, v74
    v_mul_f32 v73, 0x3a000000, v73
    v_mul_f32 v72, 0x3d800000, v72
    v_lshlrev_b32 v74, 2, v4
    v_cvt_f32_u32 v74, v74
    v_fma_f32 v84, v74, v72, v73
    v_add_f32 v85, v84, v72
    v_add_f32 v86, v85, v72
    v_add_f32 v87, v86, v72
    v_cos_f32 v72, v84
    v_sin_f32 v76, v84
    v_cos_f32 v73, v85
    v_sin_f32 v77, v85
    v_cos_f32 v74, v86
    v_sin_f32 v78, v86
    v_cos_f32 v75, v87
    v_sin_f32 v79, v87
    v_cvt_pk_bf16_f32 v84, v72, v73
    v_cvt_pk_bf16_f32 v85, v74, v75
    v_cvt_pk_bf16_f32 v86, v76, v77
    v_cvt_pk_bf16_f32 v87, v78, v79
    v_xor_b32 v88, s40, v86
    v_xor_b32 v89, s40, v87
    s_bitcmp1_b32 s3, 3
    s_cselect_b64 vcc, -1, 0
    v_cndmask_b32 v64, v84, v88, vcc
    v_cndmask_b32 v68, v88, v84, vcc
    v_cndmask_b32 v65, v85, v89, vcc
    v_cndmask_b32 v69, v89, v85, vcc
    v_cndmask_b32 v66, v86, v84, vcc
    v_cndmask_b32 v70, v84, v86, vcc
    v_cndmask_b32 v67, v87, v85, vcc
    v_cndmask_b32 v71, v85, v87, vcc
    ds_write_b128 v82, v[64:67] offset:24576
    ds_write_b128 v82, v[68:71] offset:28672
L_b_cdone:
    s_mov_b32 s46, 0x3f441b7d
    s_mov_b32 s47, 0x3e31d0d4
    s_mov_b32 s32, 0xbf708fb2
    s_mov_b32 s33, 0xbf000000
    s_mov_b32 s34, 0x3f248dbb
    s_mov_b32 s35, 0x3f7c1c5c
    s_mov_b32 s52, 0x3f5db3d7
    s_mov_b32 s53, 0x3eaf1d44
    s_waitcnt vmcnt(0)
    ds_read_b32 v84, v8 offset:0
    ds_read_b32 v85, v9 offset:128
    ds_read_b32 v86, v10 offset:256
    ds_read_b32 v87, v11 offset:384
    ds_read_b32 v88, v12 offset:512
    ds_read_b32 v89, v13 offset:640
    ds_read_b32 v90, v14 offset:768
    ds_read_b32 v91, v15 offset:896
    ds_read_b32 v92, v16 offset:1024
    s_cmp_lt_u32 s28, 2
    s_cbranch_scc1 L_noqe
    s_cmp_ge_u32 s28, 4
    s_cbranch_scc1 L_noqe
    buffer_load_dword v202, v202, s[20:23], s31 offen
L_noqe:
    s_cmp_eq_u32 s45, 2
    s_cbranch_scc1 L_b_noh
    v_lshlrev_b32 v200, 4, v2
    s_mov_b32 s24, s48
    s_and_b32 s25, s49, 0xffff
    s_mov_b32 s26, 2359296
    s_mov_b32 s27, 0x20000
    buffer_load_dwordx4 v[208:211], v200, s[24:27], s62 offen
    buffer_load_dwordx4 v[212:215], v200, s[24:27], s62 offen offset:1024
L_b_noh:
    s_waitcnt lgkmcnt(8)
    v_lshlrev_b32 v94, 16, v84
    v_and_b32 v97, 0xffff0000, v84
    s_waitcnt lgkmcnt(7)
    v_lshlrev_b32 v96, 16, v85
    v_and_b32 v99, 0xffff0000, v85
    s_waitcnt lgkmcnt(6)
    v_lshlrev_b32 v98, 16, v86
    v_and_b32 v101, 0xffff0000, v86
    s_waitcnt lgkmcnt(5)
    v_lshlrev_b32 v100, 16, v87
    v_and_b32 v103, 0xffff0000, v87
    s_waitcnt lgkmcnt(4)
    v_lshlrev_b32 v102, 16, v88
    v_and_b32 v105, 0xffff0000, v88
    s_waitcnt lgkmcnt(3)
    v_lshlrev_b32 v104, 16, v89
    v_and_b32 v107, 0xffff0000, v89
    s_waitcnt lgkmcnt(2)
    v_lshlrev_b32 v106, 16, v90
    v_and_b32 v109, 0xffff0000, v90
    s_waitcnt lgkmcnt(1)
    v_lshlrev_b32 v108, 16, v91
    v_and_b32 v111, 0xffff0000, v91
    s_waitcnt lgkmcnt(0)
    v_lshlrev_b32 v110, 16, v92
    v_and_b32 v95, 0xffff0000, v92
    v_pk_add_f32 v[118:119], v[102:103], v[104:105]
    v_pk_add_f32 v[126:127], v[102:103], v[104:105] neg_lo:[0,1] neg_hi:[0,1]
    v_pk_add_f32 v[116:117], v[100:101], v[106:107]
    v_pk_add_f32 v[124:125], v[100:101], v[106:107] neg_lo:[0,1] neg_hi:[0,1]
    v_pk_add_f32 v[114:115], v[98:99], v[108:109]
    v_pk_add_f32 v[122:123], v[98:99], v[108:109] neg_lo:[0,1] neg_hi:[0,1]
    v_pk_add_f32 v[112:113], v[96:97], v[110:111]
    v_pk_add_f32 v[120:121], v[96:97], v[110:111] neg_lo:[0,1] neg_hi:[0,1]
    v_pk_fma_f32 v[146:147], v[116:117], s[32:33], v[94:95] op_sel:[0,1,0] op_sel_hi:[1,1,1]
    v_pk_add_f32 v[148:149], v[94:95], v[116:117]
    v_pk_add_f32 v[150:151], v[112:113], v[114:115]
    v_pk_mul_f32 v[152:153], v[124:125], s[52:53] op_sel:[0,0] op_sel_hi:[1,0] neg_lo:[0,1] neg_hi:[0,1]
    v_pk_add_f32 v[140:141], v[120:121], v[122:123] neg_lo:[0,1] neg_hi:[0,1]
    v_pk_add_f32 v[150:151], v[150:151], v[118:119]
    v_pk_fma_f32 v[130:131], v[112:113], s[46:47], v[146:147] op_sel:[0,0,0] op_sel_hi:[1,0,1]
    v_pk_add_f32 v[140:141], v[140:141], v[126:127]
    v_pk_add_f32 v[128:129], v[148:149], v[150:151]
    v_pk_fma_f32 v[138:139], v[150:151], s[32:33], v[148:149] op_sel:[0,1,0] op_sel_hi:[1,1,1]
    v_pk_mul_f32 v[140:141], v[140:141], s[52:53] op_sel:[0,0] op_sel_hi:[1,0] neg_lo:[0,1] neg_hi:[0,1]
    v_pk_fma_f32 v[130:131], v[114:115], s[46:47], v[130:131] op_sel:[0,1,0] op_sel_hi:[1,1,1]
    v_cvt_pk_bf16_f32 v84, v128, v129
    ds_write_b32 v17, v84 offset:0
    v_pk_fma_f32 v[132:133], v[120:121], s[34:35], v[152:153] op_sel:[0,0,0] op_sel_hi:[1,0,1] neg_lo:[0,1,0] neg_hi:[0,1,0]
    v_cvt_pk_bf16_f32 v89, v138, v139
    ds_write_b32 v17, v89 offset:10240
    v_pk_fma_f32 v[130:131], v[118:119], s[32:33], v[130:131] op_sel:[0,0,0] op_sel_hi:[1,0,1]
    v_cvt_pk_bf16_f32 v90, v140, v141
    ds_write_b32 v17, v90 offset:12288
    v_pk_fma_f32 v[132:133], v[122:123], s[34:35], v[132:133] op_sel:[0,1,0] op_sel_hi:[1,1,1] neg_lo:[0,1,0] neg_hi:[0,1,0]
    v_pk_fma_f32 v[134:135], v[112:113], s[46:47], v[146:147] op_sel:[0,1,0] op_sel_hi:[1,1,1]
    v_cvt_pk_bf16_f32 v85, v130, v131
    ds_write_b32 v17, v85 offset:2048
    v_pk_fma_f32 v[132:133], v[126:127], s[52:53], v[132:133] op_sel:[0,1,0] op_sel_hi:[1,1,1] neg_lo:[0,1,0] neg_hi:[0,1,0]
    v_pk_fma_f32 v[134:135], v[114:115], s[32:33], v[134:135] op_sel:[0,0,0] op_sel_hi:[1,0,1]
    v_pk_fma_f32 v[136:137], v[120:121], s[34:35], v[152:153] op_sel:[0,1,0] op_sel_hi:[1,1,1] neg_lo:[0,1,1] neg_hi:[0,1,1]
    v_cvt_pk_bf16_f32 v86, v132, v133
    ds_write_b32 v17, v86 offset:4096
    v_pk_fma_f32 v[134:135], v[118:119], s[46:47], v[134:135] op_sel:[0,0,0] op_sel_hi:[1,0,1]
    v_pk_fma_f32 v[136:137], v[122:123], s[52:53], v[136:137] op_sel:[0,1,0] op_sel_hi:[1,1,1] neg_lo:[0,1,0] neg_hi:[0,1,0]
    v_pk_fma_f32 v[142:143], v[112:113], s[32:33], v[146:147] op_sel:[0,0,0] op_sel_hi:[1,0,1]
    v_cvt_pk_bf16_f32 v87, v134, v135
    ds_write_b32 v17, v87 offset:6144
    v_pk_fma_f32 v[136:137], v[126:127], s[34:35], v[136:137] op_sel:[0,0,0] op_sel_hi:[1,0,1]
    v_pk_fma_f32 v[142:143], v[114:115], s[46:47], v[142:143] op_sel:[0,0,0] op_sel_hi:[1,0,1]
    v_pk_fma_f32 v[144:145], v[120:121], s[52:53], v[152:153] op_sel:[0,1,0] op_sel_hi:[1,1,1] neg_lo:[0,1,0] neg_hi:[0,1,0]
    v_cvt_pk_bf16_f32 v88, v136, v137
    ds_write_b32 v17, v88 offset:8192
    v_pk_fma_f32 v[142:143], v[118:119], s[46:47], v[142:143] op_sel:[0,1,0] op_sel_hi:[1,1,1]
    v_pk_fma_f32 v[144:145], v[122:123], s[34:35], v[144:145] op_sel:[0,0,0] op_sel_hi:[1,0,1]
    v_pk_fma_f32 v[144:145], v[126:127], s[34:35], v[144:145] op_sel:[0,1,0] op_sel_hi:[1,1,1]
    v_cvt_pk_bf16_f32 v91, v142, v143
    ds_write_b32 v17, v91 offset:14336
    v_cvt_pk_bf16_f32 v92, v144, v145
    ds_write_b32 v17, v92 offset:16384
    s_cmp_lt_u32 s28, 4
    s_cbranch_scc1 L_noqm
    s_cmp_ge_u32 s28, 5
    s_cbranch_scc1 L_noqm
    buffer_load_dword v202, v202, s[20:23], s31 offen
L_noqm:
    s_cmp_lg_u32 s30, 0
    s_waitcnt lgkmcnt(0)
    s_barrier
    s_cbranch_scc1 L_k1b_pg1
    ds_read_b128 v[84:87], v18 offset:0
    ds_read_b128 v[88:91], v19 offset:0
    ds_read_b128 v[64:67], v82 offset:24576
    ds_read_b128 v[68:71], v82 offset:28672
    ds_read_b128 v[92:95], v18 offset:2048
    ds_read_b128 v[96:99], v19 offset:2048
    ds_read_b128 v[100:103], v18 offset:4096
    ds_read_b128 v[104:107], v19 offset:4096
    ds_read_b128 v[108:111], v18 offset:6144
    ds_read_b128 v[112:115], v19 offset:6144
    ds_read_b128 v[116:119], v18 offset:8192
    ds_read_b128 v[120:123], v19 offset:8192
    s_waitcnt lgkmcnt(11)
    v_mfma_f32_16x16x32_bf16 v[124:127], v[84:87], v[40:43], 0
    v_mfma_f32_16x16x32_bf16 v[128:131], v[84:87], v[56:59], 0
    s_waitcnt lgkmcnt(10)
    v_mfma_f32_16x16x32_bf16 v[124:127], v[88:91], v[44:47], v[124:127]
    v_mfma_f32_16x16x32_bf16 v[128:131], v[88:91], v[60:63], v[128:131]
    s_waitcnt lgkmcnt(7)
    v_mfma_f32_16x16x32_bf16 v[132:135], v[92:95], v[40:43], 0
    v_mfma_f32_16x16x32_bf16 v[136:139], v[92:95], v[56:59], 0
    s_waitcnt lgkmcnt(6)
    v_mfma_f32_16x16x32_bf16 v[132:135], v[96:99], v[44:47], v[132:135]
    v_mfma_f32_16x16x32_bf16 v[136:139], v[96:99], v[60:63], v[136:139]
    s_waitcnt lgkmcnt(5)
    v_mfma_f32_16x16x32_bf16 v[132:135], v[100:103], v[48:51], v[132:135]
    v_mfma_f32_16x16x32_bf16 v[136:139], v[100:103], v[40:43], v[136:139]
    s_waitcnt lgkmcnt(4)
    v_mfma_f32_16x16x32_bf16 v[132:135], v[104:107], v[52:55], v[132:135]
    v_mfma_f32_16x16x32_bf16 v[136:139], v[104:107], v[44:47], v[136:139]
    v_cvt_pk_bf16_f32 v148, v124, v125
    v_cvt_pk_bf16_f32 v149, v126, v127
    v_cvt_pk_bf16_f32 v150, v128, v129
    v_cvt_pk_bf16_f32 v151, v130, v131
    v_xor_b32 v150, v25, v150
    v_xor_b32 v151, v25, v151
    s_nop 1
    v_mfma_f32_16x16x32_bf16 v[72:75], v[64:67], v[148:151], 0
    v_mfma_f32_16x16x32_bf16 v[76:79], v[68:71], v[148:151], 0
    s_waitcnt lgkmcnt(3)
    v_mfma_f32_16x16x32_bf16 v[140:143], v[108:111], v[40:43], 0
    v_mfma_f32_16x16x32_bf16 v[144:147], v[108:111], v[56:59], 0
    s_waitcnt lgkmcnt(2)
    v_mfma_f32_16x16x32_bf16 v[140:143], v[112:115], v[44:47], v[140:143]
    v_mfma_f32_16x16x32_bf16 v[144:147], v[112:115], v[60:63], v[144:147]
    s_waitcnt lgkmcnt(1)
    v_mfma_f32_16x16x32_bf16 v[140:143], v[116:119], v[48:51], v[140:143]
    v_mfma_f32_16x16x32_bf16 v[144:147], v[116:119], v[40:43], v[144:147]
    s_waitcnt lgkmcnt(0)
    v_mfma_f32_16x16x32_bf16 v[140:143], v[120:123], v[52:55], v[140:143]
    v_mfma_f32_16x16x32_bf16 v[144:147], v[120:123], v[44:47], v[144:147]
    v_cvt_pk_bf16_f32 v152, v132, v133
    v_cvt_pk_bf16_f32 v153, v134, v135
    v_cvt_pk_bf16_f32 v154, v136, v137
    v_cvt_pk_bf16_f32 v155, v138, v139
    v_xor_b32 v154, v23, v154
    v_xor_b32 v155, v23, v155
    s_nop 1
    v_mfma_f32_16x16x32_bf16 v[160:163], v[64:67], v[152:155], 0
    v_mfma_f32_16x16x32_bf16 v[164:167], v[68:71], v[152:155], 0
    v_cvt_pk_bf16_f32 v124, v72, v73
    v_cvt_pk_bf16_f32 v125, v74, v75
    v_cvt_pk_bf16_f32 v126, v76, v77
    v_cvt_pk_bf16_f32 v127, v78, v79
    ds_write_b128 v22, v[124:127]
    v_cvt_pk_bf16_f32 v156, v140, v141
    v_cvt_pk_bf16_f32 v157, v142, v143
    v_cvt_pk_bf16_f32 v158, v144, v145
    v_cvt_pk_bf16_f32 v159, v146, v147
    v_xor_b32 v158, v24, v158
    v_xor_b32 v159, v24, v159
    s_nop 1
    v_mfma_f32_16x16x32_bf16 v[84:87], v[64:67], v[156:159], 0
    v_mfma_f32_16x16x32_bf16 v[88:91], v[68:71], v[156:159], 0
    v_cvt_pk_bf16_f32 v132, v160, v161
    v_cvt_pk_bf16_f32 v133, v162, v163
    v_cvt_pk_bf16_f32 v134, v164, v165
    v_cvt_pk_bf16_f32 v135, v166, v167
    ds_write_b128 v20, v[132:135]
    s_nop 1
    v_cvt_pk_bf16_f32 v140, v84, v85
    v_cvt_pk_bf16_f32 v141, v86, v87
    v_cvt_pk_bf16_f32 v142, v88, v89
    v_cvt_pk_bf16_f32 v143, v90, v91
    ds_write_b128 v21, v[140:143]
    s_waitcnt lgkmcnt(0)
    s_branch L_k1b_join
L_k1b_pg1:
    ds_read_b128 v[84:87], v18 offset:10240
    ds_read_b128 v[88:91], v19 offset:10240
    ds_read_b128 v[92:95], v18 offset:12288
    ds_read_b128 v[96:99], v19 offset:12288
    ds_read_b128 v[40:43], v82 offset:0
    ds_read_b128 v[56:59], v82 offset:16384
    ds_read_b128 v[44:47], v82 offset:4096
    ds_read_b128 v[60:63], v82 offset:20480
    ds_read_b128 v[48:51], v82 offset:8192
    ds_read_b128 v[52:55], v82 offset:12288
    ds_read_b128 v[100:103], v18 offset:14336
    ds_read_b128 v[104:107], v19 offset:14336
    ds_read_b128 v[108:111], v18 offset:16384
    ds_read_b128 v[112:115], v19 offset:16384
    s_waitcnt lgkmcnt(9)
    v_mfma_f32_16x16x32_bf16 v[124:127], v[84:87], v[40:43], 0
    s_waitcnt lgkmcnt(8)
    v_mfma_f32_16x16x32_bf16 v[128:131], v[84:87], v[56:59], 0
    s_waitcnt lgkmcnt(7)
    v_mfma_f32_16x16x32_bf16 v[124:127], v[88:91], v[44:47], v[124:127]
    s_waitcnt lgkmcnt(6)
    v_mfma_f32_16x16x32_bf16 v[128:131], v[88:91], v[60:63], v[128:131]
    s_waitcnt lgkmcnt(5)
    v_mfma_f32_16x16x32_bf16 v[124:127], v[92:95], v[48:51], v[124:127]
    v_mfma_f32_16x16x32_bf16 v[128:131], v[92:95], v[40:43], v[128:131]
    s_waitcnt lgkmcnt(4)
    v_mfma_f32_16x16x32_bf16 v[124:127], v[96:99], v[52:55], v[124:127]
    v_mfma_f32_16x16x32_bf16 v[128:131], v[96:99], v[44:47], v[128:131]
    s_waitcnt lgkmcnt(3)
    v_mfma_f32_16x16x32_bf16 v[132:135], v[100:103], v[40:43], 0
    v_mfma_f32_16x16x32_bf16 v[136:139], v[100:103], v[56:59], 0
    s_waitcnt lgkmcnt(2)
    v_mfma_f32_16x16x32_bf16 v[132:135], v[104:107], v[44:47], v[132:135]
    v_mfma_f32_16x16x32_bf16 v[136:139], v[104:107], v[60:63], v[136:139]
    s_waitcnt lgkmcnt(1)
    v_mfma_f32_16x16x32_bf16 v[132:135], v[108:111], v[48:51], v[132:135]
    v_mfma_f32_16x16x32_bf16 v[136:139], v[108:111], v[40:43], v[136:139]
    s_waitcnt lgkmcnt(0)
    v_mfma_f32_16x16x32_bf16 v[132:135], v[112:115], v[52:55], v[132:135]
    v_mfma_f32_16x16x32_bf16 v[136:139], v[112:115], v[44:47], v[136:139]
    v_cvt_pk_bf16_f32 v148, v124, v125
    v_cvt_pk_bf16_f32 v149, v126, v127
    v_cvt_pk_bf16_f32 v150, v128, v129
    v_cvt_pk_bf16_f32 v151, v130, v131
    v_xor_b32 v150, v23, v150
    v_xor_b32 v151, v23, v151
    s_nop 1
    v_mfma_f32_16x16x32_bf16 v[72:75], v[64:67], v[148:151], 0
    v_mfma_f32_16x16x32_bf16 v[76:79], v[68:71], v[148:151], 0
    v_cvt_pk_bf16_f32 v152, v132, v133
    v_cvt_pk_bf16_f32 v153, v134, v135
    v_cvt_pk_bf16_f32 v154, v136, v137
    v_cvt_pk_bf16_f32 v155, v138, v139
    v_xor_b32 v154, v24, v154
    v_xor_b32 v155, v24, v155
    s_nop 1
    v_mfma_f32_16x16x32_bf16 v[160:163], v[64:67], v[152:155], 0
    v_mfma_f32_16x16x32_bf16 v[164:167], v[68:71], v[152:155], 0
    v_cvt_pk_bf16_f32 v124, v72, v73
    v_cvt_pk_bf16_f32 v125, v74, v75
    v_cvt_pk_bf16_f32 v126, v76, v77
    v_cvt_pk_bf16_f32 v127, v78, v79
    ds_write_b128 v20, v[124:127]
    s_nop 1
    v_cvt_pk_bf16_f32 v132, v160, v161
    v_cvt_pk_bf16_f32 v133, v162, v163
    v_cvt_pk_bf16_f32 v134, v164, v165
    v_cvt_pk_bf16_f32 v135, v166, v167
    ds_write_b128 v21, v[132:135]
    s_waitcnt lgkmcnt(0)
L_k1b_join:
    s_barrier
    s_cmp_eq_u32 s28, 7
    s_cbranch_scc1 L_b_nost
    ds_read_b64_tr_b16 v[84:85], v26
    ds_read_b64_tr_b16 v[86:87], v26 offset:8
    ds_read_b64_tr_b16 v[88:89], v27
    ds_read_b64_tr_b16 v[90:91], v27 offset:8
    ds_read_b64_tr_b16 v[92:93], v28
    ds_read_b64_tr_b16 v[94:95], v28 offset:8
    s_waitcnt lgkmcnt(4)
    buffer_store_dwordx4 v[84:87], v29, s[16:19], s42 offen sc1
    s_waitcnt lgkmcnt(2)
    buffer_store_dwordx4 v[88:91], v30, s[16:19], s42 offen sc1
    s_waitcnt lgkmcnt(0)
    buffer_store_dwordx4 v[92:95], v31, s[16:19], s42 offen sc1
L_b_nost:
    s_lshl_b32 s60, s3, 7
    s_add_u32 s60, s60, 20480
    s_add_u32 s63, s63, 1
    s_load_dwordx2 s[4:5], s[0:1], 0
    s_load_dwordx2 s[6:7], s[0:1], 88
    s_load_dwordx2 s[12:13], s[0:1], 104
    v_and_b32 v2, 63, v0
    s_mov_b32 s3, s44
    s_cmp_eq_u32 s45, 2
    s_cbranch_scc1 L_k2b
    s_branch L_k2a
.p2align 6
L_k1a:
    v_mov_b32 v86, 0
    v_lshlrev_b32 v87, 2, v0
    ds_write_b32 v87, v86 offset:256
    ds_write_b32 v87, v86 offset:10496
    v_lshlrev_b32 v87, 2, v2
    ds_write_b32 v87, v86
    s_waitcnt lgkmcnt(0)
    s_add_u32 s56, s46, 5013504
    s_addc_u32 s57, s47, 0
    s_load_dword s63, s[56:57], 0
    s_and_b32 s57, s57, 0xffff
    s_mov_b32 s58, 53248
    s_mov_b32 s59, 0x20000
    s_lshl_b32 s3, s29, 4
    s_lshr_b32 s60, s2, 3
    s_add_u32 s3, s3, s60
    s_cmp_lg_u32 s28, 7
    s_cbranch_scc1 L_x2
    s_lshl_b32 s33, s3, 7
    s_add_u32 s33, s33, 4096
    buffer_load_dword v63, off, s[56:59], s33 sc1
L_x2:
    s_and_b32 s61, s28, 3
    s_lshl_b32 s60, s3, 2
    s_add_u32 s60, s60, s61
    s_lshr_b32 s61, s28, 2
    s_lshr_b32 s62, s60, 1
    s_lshl_b32 s62, s62, 2
    s_load_dword s41, s[50:51], s62
    s_lshl_b32 s60, s60, 12
    s_add_u32 s62, s60, 2040
    s_load_dwordx2 s[54:55], s[48:49], s62
    s_lshl_b32 s61, s61, 11
    s_add_u32 s62, s60, s61
    v_lshlrev_b32 v67, 4, v2
    s_barrier
    s_mov_b32 s20, s46
    s_and_b32 s21, s47, 0xffff
    s_mov_b32 s22, 2359296
    s_mov_b32 s23, 0x20000
    s_mov_b32 s24, s48
    s_and_b32 s25, s49, 0xffff
    s_mov_b32 s26, 2359296
    s_mov_b32 s27, 0x20000
    buffer_load_dwordx4 v[208:211], v67, s[24:27], s62 offen
    buffer_load_dwordx4 v[212:215], v67, s[24:27], s62 offen offset:1024
    v_bfe_u32 v6, v2, 2, 2
    v_lshlrev_b32 v6, 7, v6
    v_lshrrev_b32 v7, 4, v2
    v_lshl_add_u32 v6, v7, 5, v6
    v_and_b32 v15, 3, v2
    v_lshl_add_u32 v6, v15, 3, v6
    v_add_u32 v6, s34, v6
    s_bfe_u32 s39, s31, 0x20001
    v_xor_b32 v7, s39, v15
    v_lshlrev_b32 v7, 4, v7
    v_lshrrev_b32 v10, 2, v2
    v_lshl_add_u32 v7, v10, 14, v7
    s_lshl_b32 s38, s29, 18
    s_lshl_b32 s39, s31, 7
    s_add_u32 s38, s38, s39
    s_lshl_b32 s30, s2, 1
    s_add_u32 s30, s30, s28
    s_bfe_u32 s39, s30, 0x20002
    v_xor_b32 v66, s39, v15
    v_lshlrev_b32 v66, 4, v66
    v_lshl_add_u32 v66, v10, 14, v66
    s_lshl_b32 s42, s30, 6
    s_add_u32 s42, s42, 2097152
    s_mov_b32 s40, 0xffff
    s_waitcnt vmcnt(2)
    ds_read_b64_tr_b16 v[16:17], v6 offset:0
    ds_read_b64_tr_b16 v[18:19], v6 offset:512
    ds_read_b64_tr_b16 v[20:21], v6 offset:1024
    ds_read_b64_tr_b16 v[22:23], v6 offset:1536
    ds_read_b64_tr_b16 v[24:25], v6 offset:2048
    ds_read_b64_tr_b16 v[26:27], v6 offset:3072
    ds_read_b64_tr_b16 v[28:29], v6 offset:3584
    ds_read_b64_tr_b16 v[30:31], v6 offset:4096
    ds_read_b64_tr_b16 v[32:33], v6 offset:4608
    ds_read_b64_tr_b16 v[68:69], v6 offset:5120
    ds_read_b64_tr_b16 v[70:71], v6 offset:5632
    ds_read_b64_tr_b16 v[72:73], v6 offset:6144
    ds_read_b64_tr_b16 v[74:75], v6 offset:6656
    ds_read_b64_tr_b16 v[76:77], v6 offset:7168
    v_and_b32 v10, 0xffff0000, v9
    v_bfi_b32 v11, s40, v9, v8
    v_and_b32 v12, 0xffff, v8
    v_alignbit_b32 v13, v9, v9, 16
    v_alignbit_b32 v14, v8, v8, 16
    s_waitcnt lgkmcnt(13)
    v_dot2_f32_bf16 v34, v16, v10, 0
    v_dot2_f32_bf16 v35, v17, v13, 0
    v_dot2_f32_bf16 v36, v17, v10, 0
    s_waitcnt lgkmcnt(12)
    v_dot2_f32_bf16 v37, v18, v13, 0
    v_dot2_f32_bf16 v38, v18, v10, 0
    v_dot2_f32_bf16 v39, v19, v13, 0
    v_dot2_f32_bf16 v40, v19, v10, 0
    s_waitcnt lgkmcnt(11)
    v_dot2_f32_bf16 v41, v20, v13, 0
    v_dot2c_f32_bf16 v34, v17, v11
    v_dot2c_f32_bf16 v35, v18, v14
    v_dot2c_f32_bf16 v36, v18, v11
    v_dot2c_f32_bf16 v37, v19, v14
    v_dot2c_f32_bf16 v38, v19, v11
    v_dot2c_f32_bf16 v39, v20, v14
    v_dot2c_f32_bf16 v40, v20, v11
    v_dot2c_f32_bf16 v41, v21, v14
    v_dot2c_f32_bf16 v34, v18, v12
    v_dot2c_f32_bf16 v36, v19, v12
    v_dot2c_f32_bf16 v38, v20, v12
    v_dot2c_f32_bf16 v40, v21, v12
    s_waitcnt lgkmcnt(8)
    v_lshlrev_b32 v42, 16, v26
    v_and_b32 v43, 0xffff0000, v26
    v_lshlrev_b32 v44, 16, v27
    v_and_b32 v45, 0xffff0000, v27
    s_waitcnt lgkmcnt(7)
    v_lshlrev_b32 v46, 16, v28
    v_and_b32 v47, 0xffff0000, v28
    v_lshlrev_b32 v48, 16, v29
    v_and_b32 v49, 0xffff0000, v29
    v_mul_f32 v42, v34, v42
    v_mul_f32 v43, v35, v43
    v_mul_f32 v44, v36, v44
    v_mul_f32 v45, v37, v45
    v_mul_f32 v46, v38, v46
    v_mul_f32 v47, v39, v47
    v_mul_f32 v48, v40, v48
    v_mul_f32 v49, v41, v49
    v_cvt_pk_bf16_f32 v55, v43, v42
    v_cvt_pk_bf16_f32 v54, v45, v44
    v_cvt_pk_bf16_f32 v53, v47, v46
    v_cvt_pk_bf16_f32 v52, v49, v48
    buffer_store_dwordx4 v[52:55], v7, s[20:23], s38 offen offset:0 sc1
    v_dot2_f32_bf16 v34, v20, v10, 0
    v_dot2_f32_bf16 v35, v21, v13, 0
    v_dot2_f32_bf16 v36, v21, v10, 0
    v_dot2_f32_bf16 v37, v22, v13, 0
    v_dot2_f32_bf16 v38, v22, v10, 0
    v_dot2_f32_bf16 v39, v23, v13, 0
    v_dot2_f32_bf16 v40, v23, v10, 0
    v_dot2_f32_bf16 v41, v24, v13, 0
    v_dot2c_f32_bf16 v34, v21, v11
    v_dot2c_f32_bf16 v35, v22, v14
    v_dot2c_f32_bf16 v36, v22, v11
    v_dot2c_f32_bf16 v37, v23, v14
    v_dot2c_f32_bf16 v38, v23, v11
    v_dot2c_f32_bf16 v39, v24, v14
    v_dot2c_f32_bf16 v40, v24, v11
    v_dot2c_f32_bf16 v41, v25, v14
    v_dot2c_f32_bf16 v34, v22, v12
    v_dot2c_f32_bf16 v36, v23, v12
    v_dot2c_f32_bf16 v38, v24, v12
    v_dot2c_f32_bf16 v40, v25, v12
    s_waitcnt lgkmcnt(6)
    v_lshlrev_b32 v42, 16, v30
    v_and_b32 v43, 0xffff0000, v30
    v_lshlrev_b32 v44, 16, v31
    v_and_b32 v45, 0xffff0000, v31
    s_waitcnt lgkmcnt(5)
    v_lshlrev_b32 v46, 16, v32
    v_and_b32 v47, 0xffff0000, v32
    v_lshlrev_b32 v48, 16, v33
    v_and_b32 v49, 0xffff0000, v33
    v_mul_f32 v42, v34, v42
    v_mul_f32 v43, v35, v43
    v_mul_f32 v44, v36, v44
    v_mul_f32 v45, v37, v45
    v_mul_f32 v46, v38, v46
    v_mul_f32 v47, v39, v47
    v_mul_f32 v48, v40, v48
    v_mul_f32 v49, v41, v49
    v_cvt_pk_bf16_f32 v59, v43, v42
    v_cvt_pk_bf16_f32 v58, v45, v44
    v_cvt_pk_bf16_f32 v57, v47, v46
    v_cvt_pk_bf16_f32 v56, v49, v48
    buffer_store_dwordx4 v[56:59], v7, s[20:23], s38 offen offset:64 sc1
    s_cmp_ge_u32 s28, 2
    s_cbranch_scc1 L_x3
    v_and_b32 v10, 0xffff0000, v65
    v_bfi_b32 v11, s40, v65, v64
    v_and_b32 v12, 0xffff, v64
    v_alignbit_b32 v13, v65, v65, 16
    v_alignbit_b32 v14, v64, v64, 16
    s_waitcnt lgkmcnt(4)
    v_dot2_f32_bf16 v34, v68, v10, 0
    v_dot2_f32_bf16 v35, v69, v13, 0
    v_dot2_f32_bf16 v36, v69, v10, 0
    s_waitcnt lgkmcnt(3)
    v_dot2_f32_bf16 v37, v70, v13, 0
    v_dot2_f32_bf16 v38, v70, v10, 0
    v_dot2_f32_bf16 v39, v71, v13, 0
    v_dot2_f32_bf16 v40, v71, v10, 0
    s_waitcnt lgkmcnt(2)
    v_dot2_f32_bf16 v41, v72, v13, 0
    v_dot2c_f32_bf16 v34, v69, v11
    v_dot2c_f32_bf16 v35, v70, v14
    v_dot2c_f32_bf16 v36, v70, v11
    v_dot2c_f32_bf16 v37, v71, v14
    v_dot2c_f32_bf16 v38, v71, v11
    v_dot2c_f32_bf16 v39, v72, v14
    v_dot2c_f32_bf16 v40, v72, v11
    v_dot2c_f32_bf16 v41, v73, v14
    v_dot2c_f32_bf16 v34, v70, v12
    v_dot2c_f32_bf16 v36, v71, v12
    v_dot2c_f32_bf16 v38, v72, v12
    v_dot2c_f32_bf16 v40, v73, v12
    s_waitcnt lgkmcnt(1)
    v_lshlrev_b32 v42, 16, v74
    v_and_b32 v43, 0xffff0000, v74
    v_lshlrev_b32 v44, 16, v75
    v_and_b32 v45, 0xffff0000, v75
    s_waitcnt lgkmcnt(0)
    v_lshlrev_b32 v46, 16, v76
    v_and_b32 v47, 0xffff0000, v76
    v_lshlrev_b32 v48, 16, v77
    v_and_b32 v49, 0xffff0000, v77
    v_mul_f32 v42, v34, v42
    v_mul_f32 v43, v35, v43
    v_mul_f32 v44, v36, v44
    v_mul_f32 v45, v37, v45
    v_mul_f32 v46, v38, v46
    v_mul_f32 v47, v39, v47
    v_mul_f32 v48, v40, v48
    v_mul_f32 v49, v41, v49
    v_cvt_pk_bf16_f32 v83, v43, v42
    v_cvt_pk_bf16_f32 v82, v45, v44
    v_cvt_pk_bf16_f32 v81, v47, v46
    v_cvt_pk_bf16_f32 v80, v49, v48
    buffer_store_dwordx4 v[80:83], v66, s[20:23], s42 offen sc1
L_x3:
    s_lshl_b32 s60, s3, 7
    s_add_u32 s60, s60, 4096
    s_waitcnt lgkmcnt(0)
    s_add_u32 s63, s63, 1
    s_mov_b32 s45, 0
    s_load_dwordx2 s[4:5], s[0:1], 0
    s_load_dwordx2 s[6:7], s[0:1], 88
    s_load_dwordx2 s[12:13], s[0:1], 104
    v_and_b32 v2, 63, v0
L_k2a:
    s_cmp_lg_u32 s28, 7
    s_cbranch_scc1 L_p7
    s_setprio 3
L_p7:
    v_lshlrev_b32 v3, 4, v2
    s_and_b32 s26, s28, 3
    s_lshr_b32 s27, s28, 2
    s_mul_i32 s30, s27, s45
    s_sub_u32 s31, s27, s30
    s_lshl_b32 s35, s3, 14
    v_and_b32 v1, 255, v0
    v_mul_u32_u24 v15, 1152, v1
    v_mul_u32_u24 v14, 2304, v1
    s_lshl_b32 s32, s45, 2
    s_sub_u32 s32, s27, s32
    s_add_u32 s32, s32, 4
    s_lshl_b32 s33, s3, 3
    s_mul_i32 s47, s32, 294912
    s_lshl_b32 s34, s47, 1
    s_add_u32 s47, s47, s33
    s_add_u32 s34, s34, s33
    s_mul_i32 s40, s26, 17152
    s_mul_i32 s32, s30, 2112
    s_add_u32 s40, s40, s32
    s_add_u32 s40, s40, 82432
    v_and_b32 v21, 15, v2
    v_lshrrev_b32 v22, 4, v2
    v_mul_u32_u24 v23, 4288, v22
    v_lshl_add_u32 v23, v21, 2, v23
    v_add_u32 v23, s40, v23
    v_and_b32 v17, 3, v2
    v_lshrrev_b32 v16, 2, v21
    v_lshl_add_u32 v16, v22, 1, v16
    v_mul_u32_u24 v18, 4288, v17
    v_lshlrev_b32 v16, 3, v16
    v_sub_u32 v16, v16, v18
    s_lshl_b32 s32, s31, 8
    s_add_u32 s32, s32, s40
    s_add_u32 s32, s32, 12904
    v_add_u32 v4, s32, v16
    s_lshl_b32 s32, s31, 11
    s_add_u32 s32, s32, s40
    s_add_u32 s32, s32, 64
    v_add_u32 v20, s32, v3
    s_sub_u32 s32, 1, s45
    s_sub_u32 s32, s32, s31
    s_lshl_b32 s32, s32, 10
    s_mul_i32 s33, s30, 10240
    s_add_u32 s32, s32, s33
    v_lshlrev_b32 v16, 1, v21
    v_sub_u32 v16, v16, v22
    v_add_u32 v19, 5, v16
    v_lshrrev_b32 v18, 2, v19
    v_add_u32 v18, 3, v18
    v_xor_b32 v18, s26, v18
    v_and_b32 v18, 3, v18
    v_lshl_add_u32 v18, v18, 4, s32
    v_lshl_add_u32 v8, v19, 6, v18
    v_add_u32 v19, 9, v16
    v_lshrrev_b32 v18, 2, v19
    v_add_u32 v18, 3, v18
    v_xor_b32 v18, s26, v18
    v_and_b32 v18, 3, v18
    v_lshl_add_u32 v18, v18, 4, s32
    v_lshl_add_u32 v9, v19, 6, v18
    v_add_u32 v19, 13, v16
    v_lshrrev_b32 v18, 2, v19
    v_add_u32 v18, 3, v18
    v_xor_b32 v18, s26, v18
    v_and_b32 v18, 3, v18
    v_lshl_add_u32 v18, v18, 4, s32
    v_lshl_add_u32 v10, v19, 6, v18
    v_add_u32 v19, 17, v16
    v_lshrrev_b32 v18, 2, v19
    v_add_u32 v18, 3, v18
    v_xor_b32 v18, s26, v18
    v_and_b32 v18, 3, v18
    v_lshl_add_u32 v18, v18, 4, s32
    v_lshl_add_u32 v11, v19, 6, v18
    s_lshl_b32 s32, s26, 1
    s_add_u32 s32, s32, s27
    s_cmp_lg_u32 s45, 0
    s_cselect_b32 s32, s28, s32
    s_mul_i32 s32, s32, 784
    s_add_u32 s32, s32, 20992
    v_mul_u32_u24 v16, 192, v22
    v_lshl_add_u32 v16, v21, 3, v16
    v_add_u32 v12, s32, v16
    v_bfe_u32 v16, v2, 2, 2
    v_mul_u32_u24 v16, 784, v16
    v_lshl_add_u32 v16, v22, 3, v16
    v_mul_u32_u24 v17, 192, v17
    s_lshl_b32 s32, s26, 5
    s_mul_i32 s33, s27, 6272
    s_add_u32 s32, s32, s33
    s_add_u32 s32, s32, 20992
    v_add3_u32 v13, v16, v17, s32
    s_mov_b32 s52, 0x01000100
    s_mov_b32 s53, 0x03020302
    s_lshl_b32 s43, s41, 16
    s_and_b32 s33, s41, 0xffff0000
    s_bitcmp0_b32 s28, 0
    s_cselect_b32 s33, s43, s33
    s_cmp_eq_u32 s31, 0
    s_cselect_b32 s33, s33, 0
    s_cselect_b32 s54, 0, s54
    s_cselect_b32 s55, 0, s55
    v_mov_b32 v216, s55
    v_mov_b32 v240, s54
    v_cmp_eq_u32 vcc, 0, v2
    v_lshrrev_b32 v5, 3, v2
    s_lshr_b32 s32, s3, 4
    v_mov_b32 v6, s32
    s_cmp_ge_u32 s3, 128
    s_cselect_b64 s[42:43], -1, 0
    v_cndmask_b32 v5, v6, v5, s[42:43]
    v_and_b32 v6, 7, v2
    v_lshl_add_u32 v5, v5, 4, v6
    v_lshlrev_b32 v5, 7, v5
    s_lshl_b32 s32, s45, 10
    s_sub_u32 s46, 5120, s32
    s_waitcnt lgkmcnt(0)
    s_mov_b32 s20, s12
    s_and_b32 s21, s13, 0xffff
    s_mov_b32 s22, 2359296
    s_mov_b32 s23, 0x20000
    s_mov_b32 s48, s4
    s_and_b32 s49, s5, 0xffff
    s_mov_b32 s50, 2359296
    s_mov_b32 s51, 0x20000
    s_mov_b32 s36, s6
    s_and_b32 s37, s7, 0xffff
    s_mov_b32 s38, 4718592
    s_mov_b32 s39, 0x20000
    v_mov_b32 v16, 1
    v_mov_b32 v17, 0
    v_mov_b32 v18, s63
    s_waitcnt vmcnt(0)
    s_mov_b64 exec, 1
    ds_add_rtn_u32 v16, v17, v16 offset:240
    s_waitcnt lgkmcnt(0)
    v_readfirstlane_b32 s32, v16
    s_nop 3
    s_cmp_lg_u32 s32, 7
    s_cbranch_scc1 L_a_notlast
    buffer_store_dword v18, off, s[56:59], s60 sc1
L_a_notlast:
    s_mov_b64 exec, -1
    s_movk_i32 s60, 4096
    v_mov_b32 v17, 0
    ds_write_b32 v23, v17
    v_lshlrev_b32 v21, 16, v208
    v_and_b32 v22, 0xffff0000, v208
    v_add_f32 v21, s33, v21
    v_cvt_pk_bf16_f32 v21, v21, v22
    v_cndmask_b32 v208, v208, v21, vcc
    ds_write_b128 v20, v[208:211] offset:0
    v_mov_b32_dpp v216, v211 wave_shr:1 row_mask:0xf bank_mask:0xf
    v_mov_b32_dpp v240, v210 wave_shr:1 row_mask:0xf bank_mask:0xf
    v_mov_b32_dpp v220, v211 wave_ror:1 row_mask:0xf bank_mask:0xf
    v_mov_b32_dpp v241, v210 wave_ror:1 row_mask:0xf bank_mask:0xf
    v_mov_b32 v217, v208
    v_mov_b32 v218, v209
    v_mov_b32 v219, v210
    ds_write_b128 v20, v[216:219] offset:8576
    v_alignbit_b32 v224, v208, v216, 16
    v_alignbit_b32 v225, v209, v217, 16
    v_alignbit_b32 v226, v210, v218, 16
    v_alignbit_b32 v227, v211, v219, 16
    ds_write_b128 v20, v[224:227] offset:4288
    v_alignbit_b32 v232, v216, v240, 16
    v_mov_b32 v233, v224
    v_mov_b32 v234, v225
    v_mov_b32 v235, v226
    ds_write_b128 v20, v[232:235] offset:12864
    ds_write_b128 v20, v[212:215] offset:1024
    v_mov_b32_dpp v220, v215 wave_shr:1 row_mask:0xf bank_mask:0xf
    v_mov_b32_dpp v241, v214 wave_shr:1 row_mask:0xf bank_mask:0xf
    v_mov_b32 v221, v212
    v_mov_b32 v222, v213
    v_mov_b32 v223, v214
    ds_write_b128 v20, v[220:223] offset:9600
    v_alignbit_b32 v228, v212, v220, 16
    v_alignbit_b32 v229, v213, v221, 16
    v_alignbit_b32 v230, v214, v222, 16
    v_alignbit_b32 v231, v215, v223, 16
    ds_write_b128 v20, v[228:231] offset:5312
    v_alignbit_b32 v236, v220, v241, 16
    v_mov_b32 v237, v228
    v_mov_b32 v238, v229
    v_mov_b32 v239, v230
    ds_write_b128 v20, v[236:239] offset:13888
    s_cmp_lg_u32 s28, 7
    s_cbranch_scc1 L_a_go
    s_mov_b32 s62, 200000
    s_cmp_ge_u32 s3, 128
    s_cselect_b64 exec, -1, 0xff
L_a_poll:
    buffer_load_dword v24, v5, s[56:59], s60 offen sc1
    buffer_load_dword v25, v5, s[56:59], s46 offen sc1
    s_waitcnt vmcnt(0)
    v_cmp_ne_u32 vcc, s63, v24
    v_cmp_ne_u32 s[54:55], s63, v25
    s_nop 1
    s_or_b64 vcc, vcc, s[54:55]
    s_cbranch_scc0 L_a_polled
    s_sub_u32 s62, s62, 1
    s_cbranch_scc1 L_a_polled
    s_sleep 1
    s_branch L_a_poll
L_a_polled:
    s_mov_b64 exec, -1
    s_movk_i32 s32, 2304
    s_mov_b32 m0, s32
    s_add_u32 s32, s32, 4096
    buffer_load_dwordx4 v3, s[20:23], s35 offen offset:0 sc1 lds
    buffer_load_dwordx4 v3, s[20:23], s35 offen offset:1024 sc1 lds
    buffer_load_dwordx4 v3, s[20:23], s35 offen offset:2048 sc1 lds
    buffer_load_dwordx4 v3, s[20:23], s35 offen offset:3072 sc1 lds
    s_add_u32 s35, s35, 4096
    s_mov_b32 m0, s32
    s_lshl_b32 s42, s45, 11
    s_add_u32 s32, s32, s42
    s_add_u32 s32, s32, 4096
    buffer_load_dwordx4 v3, s[20:23], s35 offen offset:0 sc1 lds
    buffer_load_dwordx4 v3, s[20:23], s35 offen offset:1024 sc1 lds
    buffer_load_dwordx4 v3, s[20:23], s35 offen offset:2048 sc1 lds
    buffer_load_dwordx4 v3, s[20:23], s35 offen offset:3072 sc1 lds
    s_lshl_b32 s42, s45, 13
    s_add_u32 s35, s35, s42
    s_add_u32 s35, s35, 4096
    s_mov_b32 m0, s32
    s_add_u32 s32, s32, 4096
    buffer_load_dwordx4 v3, s[20:23], s35 offen offset:0 sc1 lds
    buffer_load_dwordx4 v3, s[20:23], s35 offen offset:1024 sc1 lds
    buffer_load_dwordx4 v3, s[20:23], s35 offen offset:2048 sc1 lds
    buffer_load_dwordx4 v3, s[20:23], s35 offen offset:3072 sc1 lds
    s_add_u32 s35, s35, 4096
    s_mov_b32 m0, s32
    s_add_u32 s32, s32, 4096
    buffer_load_dwordx4 v3, s[20:23], s35 offen offset:0 sc1 lds
    buffer_load_dwordx4 v3, s[20:23], s35 offen offset:1024 sc1 lds
    buffer_load_dwordx4 v3, s[20:23], s35 offen offset:2048 sc1 lds
    buffer_load_dwordx4 v3, s[20:23], s35 offen offset:3072 sc1 lds
    s_add_u32 s35, s35, 4096
    s_setprio 0
L_a_go:
    v_and_b32 v2, 7, v2
    s_lshl_b32 s32, s27, 5
    v_lshl_add_u32 v2, v2, 2, s32
    s_lshl_b32 s32, s28, 2
    v_mov_b32 v1, s32
    s_waitcnt vmcnt(0) lgkmcnt(0)
    s_barrier
    s_cmp_lg_u32 s45, 0
    s_cbranch_scc1 L_helper
    s_cmp_lg_u32 s27, 0
    s_cbranch_scc1 L_main_hi
    ds_read_b128 v[144:147], v8 offset:5120
    ds_read_b64 v[128:129], v4 offset:1024
    ds_read_b64 v[130:131], v4 offset:1032
    ds_read_b128 v[176:179], v8 offset:7168
    ds_read_b64 v[160:161], v4 offset:1536
    ds_read_b64 v[162:163], v4 offset:1544
    ds_read_b64 v[96:97], v4 offset:512
    ds_read_b64 v[98:99], v4 offset:520
    ds_read_b128 v[208:211], v8 offset:9216
    ds_read_b64 v[64:65], v4 offset:0
    ds_read_b64 v[66:67], v4 offset:8
    ds_read_b128 v[112:115], v8 offset:3072
    s_waitcnt lgkmcnt(9)
    v_mfma_f32_16x16x32_bf16 v[32:35], v[128:131], v[144:147], 0
    ds_read_b64 v[192:193], v4 offset:2048
    ds_read_b64 v[194:195], v4 offset:2056
    s_waitcnt lgkmcnt(10)
    v_mfma_f32_16x16x32_bf16 v[36:39], v[128:131], v[176:179], 0
    ds_read_b128 v[80:83], v8 offset:1024
    ds_read_b128 v[148:151], v11 offset:4096
    buffer_load_dwordx2 v[26:27], v15, s[48:51], s47 offen
    s_add_u32 s47, s47, 589824
    s_waitcnt lgkmcnt(10)
    v_mfma_f32_16x16x32_bf16 v[36:39], v[160:163], v[144:147], v[36:39]
    ds_read_b64 v[132:133], v4 offset:1088
    ds_read_b64 v[134:135], v4 offset:1096
    v_mfma_f32_16x16x32_bf16 v[40:43], v[160:163], v[176:179], 0
    ds_read_b128 v[180:183], v11 offset:6144
    s_waitcnt lgkmcnt(11)
    v_mfma_f32_16x16x32_bf16 v[32:35], v[96:99], v[176:179], v[32:35]
    ds_read_b64 v[164:165], v4 offset:1600
    ds_read_b64 v[166:167], v4 offset:1608
    s_waitcnt lgkmcnt(9)
    v_mfma_f32_16x16x32_bf16 v[36:39], v[96:99], v[208:211], v[36:39]
    v_mfma_f32_16x16x32_bf16 v[44:47], v[160:163], v[208:211], 0
    ds_read_b64 v[100:101], v4 offset:576
    ds_read_b64 v[102:103], v4 offset:584
    v_mfma_f32_16x16x32_bf16 v[32:35], v[64:67], v[208:211], v[32:35]
    ds_read_b128 v[212:215], v11 offset:8192
    v_mfma_f32_16x16x32_bf16 v[32:35], v[160:163], v[112:115], v[32:35]
    s_waitcnt lgkmcnt(5)
    v_mfma_f32_16x16x32_bf16 v[36:39], v[192:195], v[112:115], v[36:39]
    ds_read_b64 v[68:69], v4 offset:64
    ds_read_b64 v[70:71], v4 offset:72
    buffer_load_dwordx2 v[28:29], v15, s[48:51], s47 offen
    s_add_u32 s47, s47, 589824
    v_mfma_f32_16x16x32_bf16 v[44:47], v[192:195], v[176:179], v[44:47]
    ds_read_b128 v[116:119], v11 offset:2048
    v_mfma_f32_16x16x32_bf16 v[32:35], v[192:195], v[80:83], v[32:35]
    ds_read_b64 v[196:197], v4 offset:2112
    ds_read_b64 v[198:199], v4 offset:2120
    v_mfma_f32_16x16x32_bf16 v[32:35], v[132:135], v[148:151], v[32:35]
    v_mfma_f32_16x16x32_bf16 v[36:39], v[132:135], v[180:183], v[36:39]
    ds_read_b128 v[84:87], v11 offset:0
    ds_read_b128 v[152:155], v10 offset:4096
    s_waitcnt lgkmcnt(7)
    v_mfma_f32_16x16x32_bf16 v[36:39], v[164:167], v[148:151], v[36:39]
    ds_read_b64 v[136:137], v4 offset:1152
    ds_read_b64 v[138:139], v4 offset:1160
    v_mfma_f32_16x16x32_bf16 v[40:43], v[164:167], v[180:183], v[40:43]
    ds_read_b128 v[184:187], v10 offset:6144
    v_mfma_f32_16x16x32_bf16 v[32:35], v[100:103], v[180:183], v[32:35]
    ds_read_b64 v[168:169], v4 offset:1664
    ds_read_b64 v[170:171], v4 offset:1672
    v_mfma_f32_16x16x32_bf16 v[36:39], v[100:103], v[212:215], v[36:39]
    v_mfma_f32_16x16x32_bf16 v[44:47], v[164:167], v[212:215], v[44:47]
    ds_read_b64 v[104:105], v4 offset:640
    ds_read_b64 v[106:107], v4 offset:648
    s_waitcnt lgkmcnt(7)
    v_mfma_f32_16x16x32_bf16 v[32:35], v[68:71], v[212:215], v[32:35]
    ds_read_b128 v[216:219], v10 offset:8192
    v_mfma_f32_16x16x32_bf16 v[32:35], v[164:167], v[116:119], v[32:35]
    v_mfma_f32_16x16x32_bf16 v[36:39], v[196:199], v[116:119], v[36:39]
    ds_read_b64 v[72:73], v4 offset:128
    ds_read_b64 v[74:75], v4 offset:136
    v_mfma_f32_16x16x32_bf16 v[44:47], v[196:199], v[180:183], v[44:47]
    ds_read_b128 v[120:123], v10 offset:2048
    v_mfma_f32_16x16x32_bf16 v[32:35], v[196:199], v[84:87], v[32:35]
    ds_read_b64 v[200:201], v4 offset:2176
    ds_read_b64 v[202:203], v4 offset:2184
    s_waitcnt lgkmcnt(6)
    v_mfma_f32_16x16x32_bf16 v[32:35], v[136:139], v[152:155], v[32:35]
    v_mfma_f32_16x16x32_bf16 v[36:39], v[136:139], v[184:187], v[36:39]
    ds_read_b128 v[88:91], v10 offset:0
    ds_read_b128 v[156:159], v9 offset:4096
    v_mfma_f32_16x16x32_bf16 v[36:39], v[168:171], v[152:155], v[36:39]
    ds_read_b64 v[140:141], v4 offset:1216
    ds_read_b64 v[142:143], v4 offset:1224
    v_mfma_f32_16x16x32_bf16 v[40:43], v[168:171], v[184:187], v[40:43]
    ds_read_b128 v[188:191], v9 offset:6144
    v_mfma_f32_16x16x32_bf16 v[32:35], v[104:107], v[184:187], v[32:35]
    ds_read_b64 v[172:173], v4 offset:1728
    ds_read_b64 v[174:175], v4 offset:1736
    s_waitcnt lgkmcnt(7)
    v_mfma_f32_16x16x32_bf16 v[36:39], v[104:107], v[216:219], v[36:39]
    v_mfma_f32_16x16x32_bf16 v[44:47], v[168:171], v[216:219], v[44:47]
    ds_read_b64 v[108:109], v4 offset:704
    ds_read_b64 v[110:111], v4 offset:712
    v_mfma_f32_16x16x32_bf16 v[32:35], v[72:75], v[216:219], v[32:35]
    ds_read_b128 v[220:223], v9 offset:8192
    v_mfma_f32_16x16x32_bf16 v[32:35], v[168:171], v[120:123], v[32:35]
    v_mfma_f32_16x16x32_bf16 v[36:39], v[200:203], v[120:123], v[36:39]
    ds_read_b64 v[76:77], v4 offset:192
    ds_read_b64 v[78:79], v4 offset:200
    v_mfma_f32_16x16x32_bf16 v[44:47], v[200:203], v[184:187], v[44:47]
    ds_read_b128 v[124:127], v9 offset:2048
    s_waitcnt lgkmcnt(6)
    v_mfma_f32_16x16x32_bf16 v[32:35], v[200:203], v[88:91], v[32:35]
    ds_read_b64 v[204:205], v4 offset:2240
    ds_read_b64 v[206:207], v4 offset:2248
    v_mfma_f32_16x16x32_bf16 v[32:35], v[140:143], v[156:159], v[32:35]
    v_mfma_f32_16x16x32_bf16 v[36:39], v[140:143], v[188:191], v[36:39]
    ds_read_b128 v[92:95], v9 offset:0
    v_mfma_f32_16x16x32_bf16 v[36:39], v[172:175], v[156:159], v[36:39]
    ds_read_b128 v[240:243], v8 offset:11264
    v_mfma_f32_16x16x32_bf16 v[40:43], v[172:175], v[188:191], v[40:43]
    ds_read_b64 v[224:225], v4 offset:2560
    ds_read_b64 v[226:227], v4 offset:2568
    s_waitcnt lgkmcnt(6)
    v_mfma_f32_16x16x32_bf16 v[32:35], v[108:111], v[188:191], v[32:35]
    ds_read_b128 v[244:247], v11 offset:10240
    v_mfma_f32_16x16x32_bf16 v[36:39], v[108:111], v[220:223], v[36:39]
    ds_read_b64 v[228:229], v4 offset:2624
    ds_read_b64 v[230:231], v4 offset:2632
    v_mfma_f32_16x16x32_bf16 v[44:47], v[172:175], v[220:223], v[44:47]
    ds_read_b128 v[248:251], v10 offset:10240
    v_mfma_f32_16x16x32_bf16 v[32:35], v[76:79], v[220:223], v[32:35]
    ds_read_b64 v[232:233], v4 offset:2688
    ds_read_b64 v[234:235], v4 offset:2696
    v_mfma_f32_16x16x32_bf16 v[32:35], v[172:175], v[124:127], v[32:35]
    ds_read_b128 v[252:255], v9 offset:10240
    s_waitcnt lgkmcnt(7)
    v_mfma_f32_16x16x32_bf16 v[36:39], v[204:207], v[124:127], v[36:39]
    ds_read_b64 v[236:237], v4 offset:2752
    ds_read_b64 v[238:239], v4 offset:2760
    v_mfma_f32_16x16x32_bf16 v[44:47], v[204:207], v[188:191], v[44:47]
    v_mfma_f32_16x16x32_bf16 v[32:35], v[204:207], v[92:95], v[32:35]
    v_mfma_f32_16x16x32_bf16 v[36:39], v[64:67], v[240:243], v[36:39]
    v_mfma_f32_16x16x32_bf16 v[36:39], v[224:227], v[80:83], v[36:39]
    s_waitcnt lgkmcnt(2)
    v_mfma_f32_16x16x32_bf16 v[36:39], v[68:71], v[244:247], v[36:39]
    v_mfma_f32_16x16x32_bf16 v[36:39], v[228:231], v[84:87], v[36:39]
    s_nop 2
    v_cvt_pk_bf16_f32 v32, v32, v33
    v_cvt_pk_bf16_f32 v33, v34, v35
    v_mfma_f32_16x16x32_bf16 v[36:39], v[72:75], v[248:251], v[36:39]
    ds_write_b64 v12, v[32:33] offset:0
    ds_write_b32 v1, v12 offset:0
    v_mfma_f32_16x16x32_bf16 v[36:39], v[232:235], v[88:91], v[36:39]
    s_waitcnt vmcnt(1)
    v_lshlrev_b32 v16, 16, v26
    v_and_b32 v17, 0xffff0000, v26
    v_lshlrev_b32 v18, 16, v27
    v_mfma_f32_16x16x32_bf16 v[36:39], v[76:79], v[252:255], v[36:39]
    v_and_b32 v19, 0xffff0000, v27
    s_waitcnt lgkmcnt(2)
    v_mfma_f32_16x16x32_bf16 v[36:39], v[236:239], v[92:95], v[36:39]
    ds_read_b32 v3, v2 offset:0
    v_mfma_f32_16x16x32_bf16 v[40:43], v[192:195], v[144:147], v[40:43]
    v_mfma_f32_16x16x32_bf16 v[40:43], v[128:131], v[208:211], v[40:43]
    v_mfma_f32_16x16x32_bf16 v[40:43], v[196:199], v[148:151], v[40:43]
    v_mfma_f32_16x16x32_bf16 v[40:43], v[132:135], v[212:215], v[40:43]
    s_nop 2
    v_cvt_pk_bf16_f32 v36, v36, v37
    v_cvt_pk_bf16_f32 v37, v38, v39
    s_waitcnt lgkmcnt(0)
    v_cmp_eq_u32 vcc, 0, v3
    s_cbranch_vccz L_ok_0_0
L_retry_0_0:
    s_sleep 1
    ds_read_b32 v3, v2 offset:0
    s_waitcnt lgkmcnt(0)
    v_cmp_eq_u32 vcc, 0, v3
    s_nop 1
    s_cbranch_vccnz L_retry_0_0
L_ok_0_0:
    v_mfma_f32_16x16x32_bf16 v[40:43], v[200:203], v[152:155], v[40:43]
    ds_write_b64 v12, v[36:37] offset:6272
    ds_write_b32 v1, v12 offset:32
    ds_read_b64_tr_b16 v[32:33], v13 offset:0
    v_mfma_f32_16x16x32_bf16 v[40:43], v[136:139], v[216:219], v[40:43]
    ds_read_b64_tr_b16 v[34:35], v13 offset:3136
    v_mfma_f32_16x16x32_bf16 v[40:43], v[204:207], v[156:159], v[40:43]
    ds_read_b128 v[176:179], v8 offset:13312
    v_mfma_f32_16x16x32_bf16 v[40:43], v[140:143], v[220:223], v[40:43]
    ds_read_b64 v[160:161], v4 offset:3072
    ds_read_b64 v[162:163], v4 offset:3080
    v_mfma_f32_16x16x32_bf16 v[40:43], v[224:227], v[112:115], v[40:43]
    ds_read_b128 v[180:183], v11 offset:12288
    v_mfma_f32_16x16x32_bf16 v[40:43], v[96:99], v[240:243], v[40:43]
    ds_read_b64 v[164:165], v4 offset:3136
    ds_read_b64 v[166:167], v4 offset:3144
    s_waitcnt lgkmcnt(6)
    v_lshlrev_b32 v20, 16, v32
    v_mfma_f32_16x16x32_bf16 v[40:43], v[228:231], v[116:119], v[40:43]
    ds_read_b128 v[184:187], v10 offset:12288
    v_and_b32 v32, 0xffff0000, v32
    v_lshlrev_b32 v21, 16, v33
    v_mfma_f32_16x16x32_bf16 v[40:43], v[100:103], v[244:247], v[40:43]
    ds_read_b64 v[168:169], v4 offset:3200
    ds_read_b64 v[170:171], v4 offset:3208
    v_and_b32 v33, 0xffff0000, v33
    v_mfma_f32_16x16x32_bf16 v[40:43], v[232:235], v[120:123], v[40:43]
    ds_read_b128 v[188:191], v9 offset:12288
    v_lshlrev_b32 v22, 16, v34
    v_and_b32 v34, 0xffff0000, v34
    v_mfma_f32_16x16x32_bf16 v[40:43], v[104:107], v[248:251], v[40:43]
    ds_read_b64 v[172:173], v4 offset:3264
    ds_read_b64 v[174:175], v4 offset:3272
    v_lshlrev_b32 v23, 16, v35
    v_mfma_f32_16x16x32_bf16 v[40:43], v[236:239], v[124:127], v[40:43]
    v_and_b32 v35, 0xffff0000, v35
    v_add_f32 v20, v20, v32
    v_add_f32 v21, v21, v33
    v_mfma_f32_16x16x32_bf16 v[40:43], v[108:111], v[252:255], v[40:43]
    v_add_f32 v22, v22, v34
    v_add_f32 v23, v23, v35
    v_mul_f32 v20, v20, v16
    s_waitcnt lgkmcnt(5)
    v_mfma_f32_16x16x32_bf16 v[40:43], v[64:67], v[176:179], v[40:43]
    v_mul_f32 v21, v21, v17
    v_mul_f32 v22, v22, v18
    v_mul_f32 v23, v23, v19
    v_mfma_f32_16x16x32_bf16 v[40:43], v[160:163], v[80:83], v[40:43]
    v_cvt_pk_bf16_f32 v26, v20, v21
    v_cvt_pk_bf16_f32 v27, v22, v23
    v_mfma_f32_16x16x32_bf16 v[40:43], v[68:71], v[180:183], v[40:43]
    buffer_store_dwordx2 v[26:27], v14, s[36:39], s34 offen
    s_add_u32 s34, s34, 1179648
    v_mfma_f32_16x16x32_bf16 v[40:43], v[164:167], v[84:87], v[40:43]
    v_mfma_f32_16x16x32_bf16 v[40:43], v[72:75], v[184:187], v[40:43]
    s_waitcnt lgkmcnt(0)
    v_mfma_f32_16x16x32_bf16 v[40:43], v[168:171], v[88:91], v[40:43]
    v_mfma_f32_16x16x32_bf16 v[40:43], v[76:79], v[188:191], v[40:43]
    v_mfma_f32_16x16x32_bf16 v[40:43], v[172:175], v[92:95], v[40:43]
    v_mfma_f32_16x16x32_bf16 v[44:47], v[224:227], v[144:147], v[44:47]
    v_mfma_f32_16x16x32_bf16 v[44:47], v[128:131], v[240:243], v[44:47]
    v_mfma_f32_16x16x32_bf16 v[44:47], v[228:231], v[148:151], v[44:47]
    v_mfma_f32_16x16x32_bf16 v[44:47], v[132:135], v[244:247], v[44:47]
    s_nop 3
    v_cvt_pk_bf16_f32 v40, v40, v41
    v_cvt_pk_bf16_f32 v41, v42, v43
    v_mfma_f32_16x16x32_bf16 v[44:47], v[232:235], v[152:155], v[44:47]
    ds_write_b64 v12, v[40:41] offset:12544
    ds_write_b32 v1, v12 offset:64
    v_mfma_f32_16x16x32_bf16 v[44:47], v[136:139], v[248:251], v[44:47]
    s_waitcnt vmcnt(1)
    v_lshlrev_b32 v16, 16, v28
    v_and_b32 v17, 0xffff0000, v28
    v_lshlrev_b32 v18, 16, v29
    v_mfma_f32_16x16x32_bf16 v[44:47], v[236:239], v[156:159], v[44:47]
    ds_read_b128 v[208:211], v8 offset:15360
    v_and_b32 v19, 0xffff0000, v29
    v_mfma_f32_16x16x32_bf16 v[44:47], v[140:143], v[252:255], v[44:47]
    ds_read_b64 v[192:193], v4 offset:3584
    ds_read_b64 v[194:195], v4 offset:3592
    ds_read_b32 v3, v2 offset:64
    v_mfma_f32_16x16x32_bf16 v[44:47], v[96:99], v[176:179], v[44:47]
    ds_read_b128 v[212:215], v11 offset:14336
    v_mfma_f32_16x16x32_bf16 v[44:47], v[160:163], v[112:115], v[44:47]
    ds_read_b64 v[196:197], v4 offset:3648
    ds_read_b64 v[198:199], v4 offset:3656
    v_mfma_f32_16x16x32_bf16 v[44:47], v[100:103], v[180:183], v[44:47]
    ds_read_b128 v[216:219], v10 offset:14336
    v_mfma_f32_16x16x32_bf16 v[44:47], v[164:167], v[116:119], v[44:47]
    ds_read_b64 v[200:201], v4 offset:3712
    ds_read_b64 v[202:203], v4 offset:3720
    s_waitcnt lgkmcnt(6)
    v_cmp_eq_u32 vcc, 0, v3
    s_cbranch_vccz L_ok_0_1
L_retry_0_1:
    s_sleep 1
    ds_read_b32 v3, v2 offset:64
    s_waitcnt lgkmcnt(0)
    v_cmp_eq_u32 vcc, 0, v3
    s_nop 1
    s_cbranch_vccnz L_retry_0_1
L_ok_0_1:
    v_mfma_f32_16x16x32_bf16 v[44:47], v[104:107], v[184:187], v[44:47]
    ds_read_b128 v[220:223], v9 offset:14336
    ds_read_b64_tr_b16 v[40:41], v13 offset:12544
    ds_read_b64_tr_b16 v[42:43], v13 offset:15680
    v_mfma_f32_16x16x32_bf16 v[44:47], v[168:171], v[120:123], v[44:47]
    ds_read_b64 v[204:205], v4 offset:3776
    ds_read_b64 v[206:207], v4 offset:3784
    v_mfma_f32_16x16x32_bf16 v[44:47], v[108:111], v[188:191], v[44:47]
    v_mfma_f32_16x16x32_bf16 v[44:47], v[172:175], v[124:127], v[44:47]
    v_mfma_f32_16x16x32_bf16 v[44:47], v[64:67], v[208:211], v[44:47]
    s_waitcnt lgkmcnt(2)
    v_lshlrev_b32 v20, 16, v40
    v_and_b32 v40, 0xffff0000, v40
    v_lshlrev_b32 v21, 16, v41
    v_mfma_f32_16x16x32_bf16 v[44:47], v[192:195], v[80:83], v[44:47]
    v_and_b32 v41, 0xffff0000, v41
    v_lshlrev_b32 v22, 16, v42
    v_and_b32 v42, 0xffff0000, v42
    v_mfma_f32_16x16x32_bf16 v[44:47], v[68:71], v[212:215], v[44:47]
    v_lshlrev_b32 v23, 16, v43
    v_and_b32 v43, 0xffff0000, v43
    v_add_f32 v20, v20, v40
    v_mfma_f32_16x16x32_bf16 v[44:47], v[196:199], v[84:87], v[44:47]
    v_add_f32 v21, v21, v41
    v_add_f32 v22, v22, v42
    v_add_f32 v23, v23, v43
    v_mfma_f32_16x16x32_bf16 v[44:47], v[72:75], v[216:219], v[44:47]
    v_mul_f32 v20, v20, v16
    v_mul_f32 v21, v21, v17
    v_mul_f32 v22, v22, v18
    v_mfma_f32_16x16x32_bf16 v[44:47], v[200:203], v[88:91], v[44:47]
    v_mul_f32 v23, v23, v19
    v_cvt_pk_bf16_f32 v28, v20, v21
    v_cvt_pk_bf16_f32 v29, v22, v23
    v_mfma_f32_16x16x32_bf16 v[44:47], v[76:79], v[220:223], v[44:47]
    buffer_store_dwordx2 v[28:29], v14, s[36:39], s34 offen
    s_waitcnt lgkmcnt(0)
    v_mfma_f32_16x16x32_bf16 v[44:47], v[204:207], v[92:95], v[44:47]
    s_nop 7
    v_cvt_pk_bf16_f32 v44, v44, v45
    v_cvt_pk_bf16_f32 v45, v46, v47
    ds_write_b64 v12, v[44:45] offset:18816
    ds_write_b32 v1, v12 offset:96
    s_endpgm
.p2align 6
L_main_hi:
    ds_read_b128 v[144:147], v8 offset:5120
    ds_read_b64 v[128:129], v4 offset:1024
    ds_read_b64 v[130:131], v4 offset:1032
    ds_read_b128 v[176:179], v8 offset:7168
    ds_read_b64 v[160:161], v4 offset:1536
    ds_read_b64 v[162:163], v4 offset:1544
    ds_read_b64 v[96:97], v4 offset:512
    ds_read_b64 v[98:99], v4 offset:520
    ds_read_b128 v[208:211], v8 offset:9216
    ds_read_b64 v[64:65], v4 offset:0
    ds_read_b64 v[66:67], v4 offset:8
    ds_read_b128 v[112:115], v8 offset:3072
    s_waitcnt lgkmcnt(9)
    v_mfma_f32_16x16x32_bf16 v[32:35], v[128:131], v[144:147], 0
    ds_read_b64 v[192:193], v4 offset:2048
    ds_read_b64 v[194:195], v4 offset:2056
    s_waitcnt lgkmcnt(10)
    v_mfma_f32_16x16x32_bf16 v[36:39], v[128:131], v[176:179], 0
    ds_read_b128 v[80:83], v8 offset:1024
    ds_read_b128 v[148:151], v11 offset:4096
    buffer_load_dwordx2 v[26:27], v15, s[48:51], s47 offen
    s_add_u32 s47, s47, 589824
    s_waitcnt lgkmcnt(10)
    v_mfma_f32_16x16x32_bf16 v[36:39], v[160:163], v[144:147], v[36:39]
    ds_read_b64 v[132:133], v4 offset:1088
    ds_read_b64 v[134:135], v4 offset:1096
    v_mfma_f32_16x16x32_bf16 v[40:43], v[160:163], v[176:179], 0
    ds_read_b128 v[180:183], v11 offset:6144
    s_waitcnt lgkmcnt(11)
    v_mfma_f32_16x16x32_bf16 v[32:35], v[96:99], v[176:179], v[32:35]
    ds_read_b64 v[164:165], v4 offset:1600
    ds_read_b64 v[166:167], v4 offset:1608
    s_waitcnt lgkmcnt(9)
    v_mfma_f32_16x16x32_bf16 v[36:39], v[96:99], v[208:211], v[36:39]
    v_mfma_f32_16x16x32_bf16 v[44:47], v[160:163], v[208:211], 0
    ds_read_b64 v[100:101], v4 offset:576
    ds_read_b64 v[102:103], v4 offset:584
    v_mfma_f32_16x16x32_bf16 v[32:35], v[64:67], v[208:211], v[32:35]
    ds_read_b128 v[212:215], v11 offset:8192
    v_mfma_f32_16x16x32_bf16 v[32:35], v[160:163], v[112:115], v[32:35]
    s_waitcnt lgkmcnt(5)
    v_mfma_f32_16x16x32_bf16 v[36:39], v[192:195], v[112:115], v[36:39]
    ds_read_b64 v[68:69], v4 offset:64
    ds_read_b64 v[70:71], v4 offset:72
    buffer_load_dwordx2 v[28:29], v15, s[48:51], s47 offen
    s_add_u32 s47, s47, 589824
    v_mfma_f32_16x16x32_bf16 v[44:47], v[192:195], v[176:179], v[44:47]
    ds_read_b128 v[116:119], v11 offset:2048
    v_mfma_f32_16x16x32_bf16 v[32:35], v[192:195], v[80:83], v[32:35]
    ds_read_b64 v[196:197], v4 offset:2112
    ds_read_b64 v[198:199], v4 offset:2120
    v_mfma_f32_16x16x32_bf16 v[32:35], v[132:135], v[148:151], v[32:35]
    v_mfma_f32_16x16x32_bf16 v[36:39], v[132:135], v[180:183], v[36:39]
    ds_read_b128 v[84:87], v11 offset:0
    ds_read_b128 v[152:155], v10 offset:4096
    s_waitcnt lgkmcnt(7)
    v_mfma_f32_16x16x32_bf16 v[36:39], v[164:167], v[148:151], v[36:39]
    ds_read_b64 v[136:137], v4 offset:1152
    ds_read_b64 v[138:139], v4 offset:1160
    v_mfma_f32_16x16x32_bf16 v[40:43], v[164:167], v[180:183], v[40:43]
    ds_read_b128 v[184:187], v10 offset:6144
    v_mfma_f32_16x16x32_bf16 v[32:35], v[100:103], v[180:183], v[32:35]
    ds_read_b64 v[168:169], v4 offset:1664
    ds_read_b64 v[170:171], v4 offset:1672
    v_mfma_f32_16x16x32_bf16 v[36:39], v[100:103], v[212:215], v[36:39]
    v_mfma_f32_16x16x32_bf16 v[44:47], v[164:167], v[212:215], v[44:47]
    ds_read_b64 v[104:105], v4 offset:640
    ds_read_b64 v[106:107], v4 offset:648
    s_waitcnt lgkmcnt(7)
    v_mfma_f32_16x16x32_bf16 v[32:35], v[68:71], v[212:215], v[32:35]
    ds_read_b128 v[216:219], v10 offset:8192
    v_mfma_f32_16x16x32_bf16 v[32:35], v[164:167], v[116:119], v[32:35]
    v_mfma_f32_16x16x32_bf16 v[36:39], v[196:199], v[116:119], v[36:39]
    ds_read_b64 v[72:73], v4 offset:128
    ds_read_b64 v[74:75], v4 offset:136
    v_mfma_f32_16x16x32_bf16 v[44:47], v[196:199], v[180:183], v[44:47]
    ds_read_b128 v[120:123], v10 offset:2048
    v_mfma_f32_16x16x32_bf16 v[32:35], v[196:199], v[84:87], v[32:35]
    ds_read_b64 v[200:201], v4 offset:2176
    ds_read_b64 v[202:203], v4 offset:2184
    s_waitcnt lgkmcnt(6)
    v_mfma_f32_16x16x32_bf16 v[32:35], v[136:139], v[152:155], v[32:35]
    v_mfma_f32_16x16x32_bf16 v[36:39], v[136:139], v[184:187], v[36:39]
    ds_read_b128 v[88:91], v10 offset:0
    ds_read_b128 v[156:159], v9 offset:4096
    v_mfma_f32_16x16x32_bf16 v[36:39], v[168:171], v[152:155], v[36:39]
    ds_read_b64 v[140:141], v4 offset:1216
    ds_read_b64 v[142:143], v4 offset:1224
    v_mfma_f32_16x16x32_bf16 v[40:43], v[168:171], v[184:187], v[40:43]
    ds_read_b128 v[188:191], v9 offset:6144
    v_mfma_f32_16x16x32_bf16 v[32:35], v[104:107], v[184:187], v[32:35]
    ds_read_b64 v[172:173], v4 offset:1728
    ds_read_b64 v[174:175], v4 offset:1736
    s_waitcnt lgkmcnt(7)
    v_mfma_f32_16x16x32_bf16 v[36:39], v[104:107], v[216:219], v[36:39]
    v_mfma_f32_16x16x32_bf16 v[44:47], v[168:171], v[216:219], v[44:47]
    ds_read_b64 v[108:109], v4 offset:704
    ds_read_b64 v[110:111], v4 offset:712
    v_mfma_f32_16x16x32_bf16 v[32:35], v[72:75], v[216:219], v[32:35]
    ds_read_b128 v[220:223], v9 offset:8192
    v_mfma_f32_16x16x32_bf16 v[32:35], v[168:171], v[120:123], v[32:35]
    v_mfma_f32_16x16x32_bf16 v[36:39], v[200:203], v[120:123], v[36:39]
    ds_read_b64 v[76:77], v4 offset:192
    ds_read_b64 v[78:79], v4 offset:200
    v_mfma_f32_16x16x32_bf16 v[44:47], v[200:203], v[184:187], v[44:47]
    ds_read_b128 v[124:127], v9 offset:2048
    s_waitcnt lgkmcnt(6)
    v_mfma_f32_16x16x32_bf16 v[32:35], v[200:203], v[88:91], v[32:35]
    ds_read_b64 v[204:205], v4 offset:2240
    ds_read_b64 v[206:207], v4 offset:2248
    v_mfma_f32_16x16x32_bf16 v[32:35], v[140:143], v[156:159], v[32:35]
    v_mfma_f32_16x16x32_bf16 v[36:39], v[140:143], v[188:191], v[36:39]
    ds_read_b128 v[92:95], v9 offset:0
    v_mfma_f32_16x16x32_bf16 v[36:39], v[172:175], v[156:159], v[36:39]
    ds_read_b128 v[240:243], v8 offset:11264
    v_mfma_f32_16x16x32_bf16 v[40:43], v[172:175], v[188:191], v[40:43]
    ds_read_b64 v[224:225], v4 offset:2560
    ds_read_b64 v[226:227], v4 offset:2568
    s_waitcnt lgkmcnt(6)
    v_mfma_f32_16x16x32_bf16 v[32:35], v[108:111], v[188:191], v[32:35]
    ds_read_b128 v[244:247], v11 offset:10240
    v_mfma_f32_16x16x32_bf16 v[36:39], v[108:111], v[220:223], v[36:39]
    ds_read_b64 v[228:229], v4 offset:2624
    ds_read_b64 v[230:231], v4 offset:2632
    v_mfma_f32_16x16x32_bf16 v[44:47], v[172:175], v[220:223], v[44:47]
    ds_read_b128 v[248:251], v10 offset:10240
    v_mfma_f32_16x16x32_bf16 v[32:35], v[76:79], v[220:223], v[32:35]
    ds_read_b64 v[232:233], v4 offset:2688
    ds_read_b64 v[234:235], v4 offset:2696
    v_mfma_f32_16x16x32_bf16 v[32:35], v[172:175], v[124:127], v[32:35]
    ds_read_b128 v[252:255], v9 offset:10240
    s_waitcnt lgkmcnt(7)
    v_mfma_f32_16x16x32_bf16 v[36:39], v[204:207], v[124:127], v[36:39]
    ds_read_b64 v[236:237], v4 offset:2752
    ds_read_b64 v[238:239], v4 offset:2760
    v_mfma_f32_16x16x32_bf16 v[44:47], v[204:207], v[188:191], v[44:47]
    v_mfma_f32_16x16x32_bf16 v[32:35], v[204:207], v[92:95], v[32:35]
    v_mfma_f32_16x16x32_bf16 v[36:39], v[64:67], v[240:243], v[36:39]
    v_mfma_f32_16x16x32_bf16 v[36:39], v[224:227], v[80:83], v[36:39]
    s_waitcnt lgkmcnt(2)
    v_mfma_f32_16x16x32_bf16 v[36:39], v[68:71], v[244:247], v[36:39]
    v_mfma_f32_16x16x32_bf16 v[36:39], v[228:231], v[84:87], v[36:39]
    s_nop 2
    v_cvt_pk_bf16_f32 v32, v32, v33
    v_cvt_pk_bf16_f32 v33, v34, v35
    v_mfma_f32_16x16x32_bf16 v[36:39], v[72:75], v[248:251], v[36:39]
    ds_write_b64 v12, v[32:33] offset:0
    ds_write_b32 v1, v12 offset:0
    v_mfma_f32_16x16x32_bf16 v[36:39], v[232:235], v[88:91], v[36:39]
    v_mfma_f32_16x16x32_bf16 v[36:39], v[76:79], v[252:255], v[36:39]
    s_waitcnt lgkmcnt(2)
    v_mfma_f32_16x16x32_bf16 v[36:39], v[236:239], v[92:95], v[36:39]
    v_mfma_f32_16x16x32_bf16 v[40:43], v[192:195], v[144:147], v[40:43]
    v_mfma_f32_16x16x32_bf16 v[40:43], v[128:131], v[208:211], v[40:43]
    v_mfma_f32_16x16x32_bf16 v[40:43], v[196:199], v[148:151], v[40:43]
    v_mfma_f32_16x16x32_bf16 v[40:43], v[132:135], v[212:215], v[40:43]
    s_nop 3
    v_cvt_pk_bf16_f32 v36, v36, v37
    v_cvt_pk_bf16_f32 v37, v38, v39
    v_mfma_f32_16x16x32_bf16 v[40:43], v[200:203], v[152:155], v[40:43]
    ds_write_b64 v12, v[36:37] offset:6272
    ds_write_b32 v1, v12 offset:32
    v_mfma_f32_16x16x32_bf16 v[40:43], v[136:139], v[216:219], v[40:43]
    s_waitcnt vmcnt(1)
    v_lshlrev_b32 v16, 16, v26
    v_and_b32 v17, 0xffff0000, v26
    v_lshlrev_b32 v18, 16, v27
    v_mfma_f32_16x16x32_bf16 v[40:43], v[204:207], v[156:159], v[40:43]
    ds_read_b128 v[176:179], v8 offset:13312
    v_and_b32 v19, 0xffff0000, v27
    v_mfma_f32_16x16x32_bf16 v[40:43], v[140:143], v[220:223], v[40:43]
    ds_read_b64 v[160:161], v4 offset:3072
    ds_read_b64 v[162:163], v4 offset:3080
    ds_read_b32 v3, v2 offset:0
    v_mfma_f32_16x16x32_bf16 v[40:43], v[224:227], v[112:115], v[40:43]
    ds_read_b128 v[180:183], v11 offset:12288
    v_mfma_f32_16x16x32_bf16 v[40:43], v[96:99], v[240:243], v[40:43]
    ds_read_b64 v[164:165], v4 offset:3136
    ds_read_b64 v[166:167], v4 offset:3144
    v_mfma_f32_16x16x32_bf16 v[40:43], v[228:231], v[116:119], v[40:43]
    ds_read_b128 v[184:187], v10 offset:12288
    v_mfma_f32_16x16x32_bf16 v[40:43], v[100:103], v[244:247], v[40:43]
    ds_read_b64 v[168:169], v4 offset:3200
    ds_read_b64 v[170:171], v4 offset:3208
    s_waitcnt lgkmcnt(6)
    v_cmp_eq_u32 vcc, 0, v3
    s_cbranch_vccz L_ok_1_0
L_retry_1_0:
    s_sleep 1
    ds_read_b32 v3, v2 offset:0
    s_waitcnt lgkmcnt(0)
    v_cmp_eq_u32 vcc, 0, v3
    s_nop 1
    s_cbranch_vccnz L_retry_1_0
L_ok_1_0:
    v_mfma_f32_16x16x32_bf16 v[40:43], v[232:235], v[120:123], v[40:43]
    ds_read_b128 v[188:191], v9 offset:12288
    ds_read_b64_tr_b16 v[36:37], v13 offset:0
    ds_read_b64_tr_b16 v[38:39], v13 offset:3136
    v_mfma_f32_16x16x32_bf16 v[40:43], v[104:107], v[248:251], v[40:43]
    ds_read_b64 v[172:173], v4 offset:3264
    ds_read_b64 v[174:175], v4 offset:3272
    v_mfma_f32_16x16x32_bf16 v[40:43], v[236:239], v[124:127], v[40:43]
    v_mfma_f32_16x16x32_bf16 v[40:43], v[108:111], v[252:255], v[40:43]
    v_mfma_f32_16x16x32_bf16 v[40:43], v[64:67], v[176:179], v[40:43]
    s_waitcnt lgkmcnt(2)
    v_lshlrev_b32 v20, 16, v36
    v_and_b32 v36, 0xffff0000, v36
    v_lshlrev_b32 v21, 16, v37
    v_mfma_f32_16x16x32_bf16 v[40:43], v[160:163], v[80:83], v[40:43]
    v_and_b32 v37, 0xffff0000, v37
    v_lshlrev_b32 v22, 16, v38
    v_and_b32 v38, 0xffff0000, v38
    v_mfma_f32_16x16x32_bf16 v[40:43], v[68:71], v[180:183], v[40:43]
    v_lshlrev_b32 v23, 16, v39
    v_and_b32 v39, 0xffff0000, v39
    v_add_f32 v20, v20, v36
    v_mfma_f32_16x16x32_bf16 v[40:43], v[164:167], v[84:87], v[40:43]
    v_add_f32 v21, v21, v37
    v_add_f32 v22, v22, v38
    v_add_f32 v23, v23, v39
    v_mfma_f32_16x16x32_bf16 v[40:43], v[72:75], v[184:187], v[40:43]
    v_mul_f32 v20, v20, v16
    v_mul_f32 v21, v21, v17
    v_mul_f32 v22, v22, v18
    v_mfma_f32_16x16x32_bf16 v[40:43], v[168:171], v[88:91], v[40:43]
    v_mul_f32 v23, v23, v19
    v_cvt_pk_bf16_f32 v26, v20, v21
    v_cvt_pk_bf16_f32 v27, v22, v23
    v_mfma_f32_16x16x32_bf16 v[40:43], v[76:79], v[188:191], v[40:43]
    buffer_store_dwordx2 v[26:27], v14, s[36:39], s34 offen
    s_add_u32 s34, s34, 1179648
    s_waitcnt lgkmcnt(0)
    v_mfma_f32_16x16x32_bf16 v[40:43], v[172:175], v[92:95], v[40:43]
    v_mfma_f32_16x16x32_bf16 v[44:47], v[224:227], v[144:147], v[44:47]
    v_mfma_f32_16x16x32_bf16 v[44:47], v[128:131], v[240:243], v[44:47]
    v_mfma_f32_16x16x32_bf16 v[44:47], v[228:231], v[148:151], v[44:47]
    v_mfma_f32_16x16x32_bf16 v[44:47], v[132:135], v[244:247], v[44:47]
    s_nop 3
    v_cvt_pk_bf16_f32 v40, v40, v41
    v_cvt_pk_bf16_f32 v41, v42, v43
    v_mfma_f32_16x16x32_bf16 v[44:47], v[232:235], v[152:155], v[44:47]
    ds_write_b64 v12, v[40:41] offset:12544
    ds_write_b32 v1, v12 offset:64
    v_mfma_f32_16x16x32_bf16 v[44:47], v[136:139], v[248:251], v[44:47]
    v_mfma_f32_16x16x32_bf16 v[44:47], v[236:239], v[156:159], v[44:47]
    ds_read_b128 v[208:211], v8 offset:15360
    v_mfma_f32_16x16x32_bf16 v[44:47], v[140:143], v[252:255], v[44:47]
    ds_read_b64 v[192:193], v4 offset:3584
    ds_read_b64 v[194:195], v4 offset:3592
    v_mfma_f32_16x16x32_bf16 v[44:47], v[96:99], v[176:179], v[44:47]
    ds_read_b128 v[212:215], v11 offset:14336
    v_mfma_f32_16x16x32_bf16 v[44:47], v[160:163], v[112:115], v[44:47]
    ds_read_b64 v[196:197], v4 offset:3648
    ds_read_b64 v[198:199], v4 offset:3656
    v_mfma_f32_16x16x32_bf16 v[44:47], v[100:103], v[180:183], v[44:47]
    ds_read_b128 v[216:219], v10 offset:14336
    v_mfma_f32_16x16x32_bf16 v[44:47], v[164:167], v[116:119], v[44:47]
    ds_read_b64 v[200:201], v4 offset:3712
    ds_read_b64 v[202:203], v4 offset:3720
    v_mfma_f32_16x16x32_bf16 v[44:47], v[104:107], v[184:187], v[44:47]
    ds_read_b128 v[220:223], v9 offset:14336
    v_mfma_f32_16x16x32_bf16 v[44:47], v[168:171], v[120:123], v[44:47]
    ds_read_b64 v[204:205], v4 offset:3776
    ds_read_b64 v[206:207], v4 offset:3784
    v_mfma_f32_16x16x32_bf16 v[44:47], v[108:111], v[188:191], v[44:47]
    s_waitcnt vmcnt(1)
    v_perm_b32 v16, v28, v28, s52
    v_perm_b32 v17, v28, v28, s53
    v_perm_b32 v18, v29, v29, s52
    v_mfma_f32_16x16x32_bf16 v[44:47], v[172:175], v[124:127], v[44:47]
    v_perm_b32 v19, v29, v29, s53
    s_waitcnt lgkmcnt(5)
    v_mfma_f32_16x16x32_bf16 v[44:47], v[64:67], v[208:211], v[44:47]
    v_mfma_f32_16x16x32_bf16 v[44:47], v[192:195], v[80:83], v[44:47]
    v_mfma_f32_16x16x32_bf16 v[44:47], v[68:71], v[212:215], v[44:47]
    v_mfma_f32_16x16x32_bf16 v[44:47], v[196:199], v[84:87], v[44:47]
    v_mfma_f32_16x16x32_bf16 v[44:47], v[72:75], v[216:219], v[44:47]
    s_waitcnt lgkmcnt(0)
    v_mfma_f32_16x16x32_bf16 v[44:47], v[200:203], v[88:91], v[44:47]
    v_mfma_f32_16x16x32_bf16 v[44:47], v[76:79], v[220:223], v[44:47]
    v_mfma_f32_16x16x32_bf16 v[44:47], v[204:207], v[92:95], v[44:47]
    s_nop 7
    v_cvt_pk_bf16_f32 v44, v44, v45
    v_cvt_pk_bf16_f32 v45, v46, v47
    ds_write_b64 v12, v[44:45] offset:18816
    ds_write_b32 v1, v12 offset:96
    ds_read_b32 v3, v2 offset:64
    s_waitcnt lgkmcnt(0)
    v_cmp_eq_u32 vcc, 0, v3
    s_cbranch_vccz L_ok_1_1
L_retry_1_1:
    ds_read_b32 v3, v2 offset:64
    s_waitcnt lgkmcnt(0)
    v_cmp_eq_u32 vcc, 0, v3
    s_nop 1
    s_cbranch_vccnz L_retry_1_1
L_ok_1_1:
    ds_read_b64_tr_b16 v[44:45], v13 offset:12544
    ds_read_b64_tr_b16 v[46:47], v13 offset:15680
    s_waitcnt lgkmcnt(0)
    v_dot2_f32_bf16 v20, v44, v16, 0
    v_dot2_f32_bf16 v21, v45, v17, 0
    v_dot2_f32_bf16 v22, v46, v18, 0
    v_dot2_f32_bf16 v23, v47, v19, 0
    s_nop 0
    v_cvt_pk_bf16_f32 v28, v20, v21
    s_nop 0
    v_cvt_pk_bf16_f32 v29, v22, v23
    buffer_store_dwordx2 v[28:29], v14, s[36:39], s34 offen
    s_endpgm
.p2align 6
L_helper:
    ds_read_b128 v[128:131], v8 offset:2048
    ds_read_b64 v[64:65], v4 offset:0
    ds_read_b64 v[66:67], v4 offset:8
    ds_read_b128 v[160:163], v8 offset:4096
    ds_read_b64 v[96:97], v4 offset:512
    ds_read_b64 v[98:99], v4 offset:520
    ds_read_b128 v[132:135], v11 offset:1024
    ds_read_b64 v[68:69], v4 offset:64
    ds_read_b64 v[70:71], v4 offset:72
    ds_read_b128 v[164:167], v11 offset:3072
    ds_read_b64 v[100:101], v4 offset:576
    ds_read_b64 v[102:103], v4 offset:584
    s_waitcnt lgkmcnt(9)
    v_mfma_f32_16x16x32_bf16 v[32:35], v[64:67], v[128:131], 0
    ds_read_b128 v[136:139], v10 offset:1024
    ds_read_b64 v[72:73], v4 offset:128
    s_waitcnt lgkmcnt(10)
    v_mfma_f32_16x16x32_bf16 v[36:39], v[64:67], v[160:163], 0
    ds_read_b64 v[74:75], v4 offset:136
    ds_read_b128 v[168:171], v10 offset:3072
    buffer_load_dwordx4 v[16:19], v15, s[48:51], s47 offen
    s_add_u32 s47, s47, 589824
    s_waitcnt lgkmcnt(10)
    v_mfma_f32_16x16x32_bf16 v[36:39], v[96:99], v[128:131], v[36:39]
    ds_read_b64 v[104:105], v4 offset:640
    ds_read_b64 v[106:107], v4 offset:648
    v_mfma_f32_16x16x32_bf16 v[40:43], v[96:99], v[160:163], 0
    ds_read_b128 v[140:143], v9 offset:1024
    ds_read_b64 v[76:77], v4 offset:192
    s_waitcnt lgkmcnt(11)
    v_mfma_f32_16x16x32_bf16 v[32:35], v[68:71], v[132:135], v[32:35]
    ds_read_b64 v[78:79], v4 offset:200
    ds_read_b128 v[172:175], v9 offset:3072
    s_waitcnt lgkmcnt(10)
    v_mfma_f32_16x16x32_bf16 v[36:39], v[68:71], v[164:167], v[36:39]
    ds_read_b64 v[108:109], v4 offset:704
    ds_read_b64 v[110:111], v4 offset:712
    v_mfma_f32_16x16x32_bf16 v[36:39], v[100:103], v[132:135], v[36:39]
    ds_read_b128 v[144:147], v8 offset:1024
    ds_read_b64 v[80:81], v4 offset:256
    v_mfma_f32_16x16x32_bf16 v[40:43], v[100:103], v[164:167], v[40:43]
    ds_read_b64 v[82:83], v4 offset:264
    ds_read_b128 v[176:179], v8 offset:3072
    s_waitcnt lgkmcnt(10)
    v_mfma_f32_16x16x32_bf16 v[32:35], v[72:75], v[136:139], v[32:35]
    ds_read_b64 v[112:113], v4 offset:768
    ds_read_b64 v[114:115], v4 offset:776
    v_mfma_f32_16x16x32_bf16 v[36:39], v[72:75], v[168:171], v[36:39]
    ds_read_b128 v[148:151], v11 offset:0
    buffer_load_dwordx4 v[20:23], v15, s[48:51], s47 offen
    s_add_u32 s47, s47, 589824
    v_mfma_f32_16x16x32_bf16 v[36:39], v[104:107], v[136:139], v[36:39]
    ds_read_b64 v[84:85], v4 offset:320
    ds_read_b64 v[86:87], v4 offset:328
    v_mfma_f32_16x16x32_bf16 v[40:43], v[104:107], v[168:171], v[40:43]
    ds_read_b128 v[180:183], v11 offset:2048
    s_waitcnt lgkmcnt(8)
    v_mfma_f32_16x16x32_bf16 v[32:35], v[76:79], v[140:143], v[32:35]
    ds_read_b64 v[116:117], v4 offset:832
    ds_read_b64 v[118:119], v4 offset:840
    v_mfma_f32_16x16x32_bf16 v[36:39], v[76:79], v[172:175], v[36:39]
    ds_read_b128 v[152:155], v10 offset:0
    v_mfma_f32_16x16x32_bf16 v[36:39], v[108:111], v[140:143], v[36:39]
    ds_read_b64 v[88:89], v4 offset:384
    ds_read_b64 v[90:91], v4 offset:392
    v_mfma_f32_16x16x32_bf16 v[40:43], v[108:111], v[172:175], v[40:43]
    ds_read_b128 v[184:187], v10 offset:2048
    s_waitcnt lgkmcnt(7)
    v_mfma_f32_16x16x32_bf16 v[32:35], v[80:83], v[144:147], v[32:35]
    ds_read_b64 v[120:121], v4 offset:896
    ds_read_b64 v[122:123], v4 offset:904
    v_mfma_f32_16x16x32_bf16 v[36:39], v[80:83], v[176:179], v[36:39]
    ds_read_b128 v[156:159], v9 offset:0
    v_mfma_f32_16x16x32_bf16 v[36:39], v[112:115], v[144:147], v[36:39]
    ds_read_b64 v[92:93], v4 offset:448
    ds_read_b64 v[94:95], v4 offset:456
    v_mfma_f32_16x16x32_bf16 v[40:43], v[112:115], v[176:179], v[40:43]
    ds_read_b128 v[188:191], v9 offset:2048
    v_mfma_f32_16x16x32_bf16 v[32:35], v[84:87], v[148:151], v[32:35]
    ds_read_b64 v[124:125], v4 offset:960
    ds_read_b64 v[126:127], v4 offset:968
    s_waitcnt lgkmcnt(8)
    v_mfma_f32_16x16x32_bf16 v[36:39], v[84:87], v[180:183], v[36:39]
    v_mfma_f32_16x16x32_bf16 v[36:39], v[116:119], v[148:151], v[36:39]
    ds_read_b128 v[200:203], v8 offset:6144
    v_mfma_f32_16x16x32_bf16 v[40:43], v[116:119], v[180:183], v[40:43]
    v_mfma_f32_16x16x32_bf16 v[32:35], v[88:91], v[152:155], v[32:35]
    ds_read_b128 v[204:207], v8 offset:8192
    v_mfma_f32_16x16x32_bf16 v[36:39], v[88:91], v[184:187], v[36:39]
    ds_read_b64 v[192:193], v4 offset:1024
    ds_read_b64 v[194:195], v4 offset:1032
    s_waitcnt lgkmcnt(4)
    v_mfma_f32_16x16x32_bf16 v[36:39], v[120:123], v[152:155], v[36:39]
    v_mfma_f32_16x16x32_bf16 v[40:43], v[120:123], v[184:187], v[40:43]
    ds_read_b64 v[196:197], v4 offset:1536
    ds_read_b64 v[198:199], v4 offset:1544
    v_mfma_f32_16x16x32_bf16 v[32:35], v[92:95], v[156:159], v[32:35]
    ds_read_b128 v[216:219], v11 offset:5120
    v_mfma_f32_16x16x32_bf16 v[36:39], v[92:95], v[188:191], v[36:39]
    v_mfma_f32_16x16x32_bf16 v[36:39], v[124:127], v[156:159], v[36:39]
    ds_read_b128 v[220:223], v11 offset:7168
    v_mfma_f32_16x16x32_bf16 v[40:43], v[124:127], v[188:191], v[40:43]
    ds_read_b64 v[208:209], v4 offset:1088
    ds_read_b64 v[210:211], v4 offset:1096
    s_waitcnt lgkmcnt(6)
    v_mfma_f32_16x16x32_bf16 v[40:43], v[64:67], v[200:203], v[40:43]
    v_cvt_pk_bf16_f32 v32, v32, v33
    v_cvt_pk_bf16_f32 v33, v34, v35
    v_mfma_f32_16x16x32_bf16 v[44:47], v[96:99], v[200:203], 0
    ds_read_b64 v[212:213], v4 offset:1600
    ds_read_b64 v[214:215], v4 offset:1608
    ds_write_b64 v12, v[32:33] offset:0
    v_mfma_f32_16x16x32_bf16 v[44:47], v[64:67], v[204:207], v[44:47]
    ds_read_b128 v[232:235], v10 offset:5120
    ds_write_b32 v1, v12 offset:0
    v_cvt_pk_bf16_f32 v36, v36, v37
    v_mfma_f32_16x16x32_bf16 v[40:43], v[192:195], v[128:131], v[40:43]
    v_cvt_pk_bf16_f32 v37, v38, v39
    v_mfma_f32_16x16x32_bf16 v[44:47], v[192:195], v[160:163], v[44:47]
    ds_read_b128 v[236:239], v10 offset:7168
    ds_write_b64 v12, v[36:37] offset:6272
    ds_write_b32 v1, v12 offset:32
    s_waitcnt lgkmcnt(8)
    v_mfma_f32_16x16x32_bf16 v[44:47], v[196:199], v[128:131], v[44:47]
    ds_read_b64 v[224:225], v4 offset:1152
    ds_read_b64 v[226:227], v4 offset:1160
    s_waitcnt vmcnt(1)
    v_lshlrev_b32 v48, 16, v16
    v_mfma_f32_16x16x32_bf16 v[40:43], v[68:71], v[216:219], v[40:43]
    v_and_b32 v49, 0xffff0000, v16
    v_lshlrev_b32 v50, 16, v17
    v_and_b32 v51, 0xffff0000, v17
    v_mfma_f32_16x16x32_bf16 v[44:47], v[100:103], v[216:219], v[44:47]
    ds_read_b64 v[228:229], v4 offset:1664
    ds_read_b64 v[230:231], v4 offset:1672
    ds_read_b32 v3, v2 offset:0
    v_mfma_f32_16x16x32_bf16 v[44:47], v[68:71], v[220:223], v[44:47]
    ds_read_b128 v[248:251], v9 offset:5120
    v_lshlrev_b32 v52, 16, v18
    v_and_b32 v53, 0xffff0000, v18
    v_mfma_f32_16x16x32_bf16 v[40:43], v[208:211], v[132:135], v[40:43]
    v_lshlrev_b32 v54, 16, v19
    v_and_b32 v55, 0xffff0000, v19
    v_mfma_f32_16x16x32_bf16 v[44:47], v[208:211], v[164:167], v[44:47]
    ds_read_b128 v[252:255], v9 offset:7168
    s_waitcnt lgkmcnt(5)
    v_mfma_f32_16x16x32_bf16 v[44:47], v[212:215], v[132:135], v[44:47]
    ds_read_b64 v[240:241], v4 offset:1216
    ds_read_b64 v[242:243], v4 offset:1224
    s_waitcnt lgkmcnt(4)
    v_cmp_eq_u32 vcc, 0, v3
    s_cbranch_vccz L_ok_h_0
L_retry_h_0:
    s_sleep 1
    ds_read_b32 v3, v2 offset:0
    s_waitcnt lgkmcnt(0)
    v_cmp_eq_u32 vcc, 0, v3
    s_nop 1
    s_cbranch_vccnz L_retry_h_0
L_ok_h_0:
    v_mfma_f32_16x16x32_bf16 v[40:43], v[72:75], v[232:235], v[40:43]
    ds_read_b64_tr_b16 v[36:37], v13 offset:0
    ds_read_b64_tr_b16 v[38:39], v13 offset:3136
    v_mfma_f32_16x16x32_bf16 v[44:47], v[104:107], v[232:235], v[44:47]
    ds_read_b64 v[244:245], v4 offset:1728
    ds_read_b64 v[246:247], v4 offset:1736
    v_mfma_f32_16x16x32_bf16 v[44:47], v[72:75], v[236:239], v[44:47]
    ds_read_b128 v[200:203], v8 offset:5120
    v_mfma_f32_16x16x32_bf16 v[40:43], v[224:227], v[136:139], v[40:43]
    v_mfma_f32_16x16x32_bf16 v[44:47], v[224:227], v[168:171], v[44:47]
    ds_read_b128 v[204:207], v8 offset:7168
    s_waitcnt lgkmcnt(4)
    v_lshlrev_b32 v56, 16, v36
    v_and_b32 v57, 0xffff0000, v36
    v_mfma_f32_16x16x32_bf16 v[44:47], v[228:231], v[136:139], v[44:47]
    ds_read_b64 v[192:193], v4 offset:1280
    ds_read_b64 v[194:195], v4 offset:1288
    v_lshlrev_b32 v58, 16, v37
    v_mfma_f32_16x16x32_bf16 v[40:43], v[76:79], v[248:251], v[40:43]
    v_and_b32 v59, 0xffff0000, v37
    v_lshlrev_b32 v60, 16, v38
    v_and_b32 v61, 0xffff0000, v38
    v_mfma_f32_16x16x32_bf16 v[44:47], v[108:111], v[248:251], v[44:47]
    ds_read_b64 v[196:197], v4 offset:1792
    ds_read_b64 v[198:199], v4 offset:1800
    v_lshlrev_b32 v62, 16, v39
    v_mfma_f32_16x16x32_bf16 v[44:47], v[76:79], v[252:255], v[44:47]
    ds_read_b128 v[216:219], v11 offset:4096
    v_and_b32 v63, 0xffff0000, v39
    v_mul_f32 v56, v56, v48
    v_mfma_f32_16x16x32_bf16 v[40:43], v[240:243], v[140:143], v[40:43]
    v_mul_f32 v57, v57, v49
    v_mul_f32 v58, v58, v50
    v_mul_f32 v59, v59, v51
    v_mfma_f32_16x16x32_bf16 v[44:47], v[240:243], v[172:175], v[44:47]
    ds_read_b128 v[220:223], v11 offset:6144
    v_mul_f32 v60, v60, v52
    v_mul_f32 v61, v61, v53
    s_waitcnt lgkmcnt(4)
    v_mfma_f32_16x16x32_bf16 v[44:47], v[244:247], v[140:143], v[44:47]
    ds_read_b64 v[208:209], v4 offset:1344
    ds_read_b64 v[210:211], v4 offset:1352
    v_mul_f32 v62, v62, v54
    v_mfma_f32_16x16x32_bf16 v[40:43], v[80:83], v[200:203], v[40:43]
    v_mul_f32 v63, v63, v55
    v_cvt_pk_bf16_f32 v16, v56, v57
    v_cvt_pk_bf16_f32 v17, v58, v59
    v_mfma_f32_16x16x32_bf16 v[44:47], v[112:115], v[200:203], v[44:47]
    ds_read_b64 v[212:213], v4 offset:1856
    ds_read_b64 v[214:215], v4 offset:1864
    v_cvt_pk_bf16_f32 v18, v60, v61
    v_mfma_f32_16x16x32_bf16 v[44:47], v[80:83], v[204:207], v[44:47]
    ds_read_b128 v[232:235], v10 offset:4096
    v_cvt_pk_bf16_f32 v19, v62, v63
    v_mfma_f32_16x16x32_bf16 v[40:43], v[192:195], v[144:147], v[40:43]
    buffer_store_dwordx4 v[16:19], v14, s[36:39], s34 offen
    s_add_u32 s34, s34, 1179648
    v_mfma_f32_16x16x32_bf16 v[44:47], v[192:195], v[176:179], v[44:47]
    ds_read_b128 v[236:239], v10 offset:6144
    s_waitcnt lgkmcnt(4)
    v_mfma_f32_16x16x32_bf16 v[44:47], v[196:199], v[144:147], v[44:47]
    ds_read_b64 v[224:225], v4 offset:1408
    ds_read_b64 v[226:227], v4 offset:1416
    v_mfma_f32_16x16x32_bf16 v[40:43], v[84:87], v[216:219], v[40:43]
    v_mfma_f32_16x16x32_bf16 v[44:47], v[116:119], v[216:219], v[44:47]
    ds_read_b64 v[228:229], v4 offset:1920
    ds_read_b64 v[230:231], v4 offset:1928
    v_mfma_f32_16x16x32_bf16 v[44:47], v[84:87], v[220:223], v[44:47]
    ds_read_b128 v[248:251], v9 offset:4096
    v_mfma_f32_16x16x32_bf16 v[40:43], v[208:211], v[148:151], v[40:43]
    v_mfma_f32_16x16x32_bf16 v[44:47], v[208:211], v[180:183], v[44:47]
    ds_read_b128 v[252:255], v9 offset:6144
    s_waitcnt lgkmcnt(4)
    v_mfma_f32_16x16x32_bf16 v[44:47], v[212:215], v[148:151], v[44:47]
    ds_read_b64 v[240:241], v4 offset:1472
    ds_read_b64 v[242:243], v4 offset:1480
    v_mfma_f32_16x16x32_bf16 v[40:43], v[88:91], v[232:235], v[40:43]
    v_mfma_f32_16x16x32_bf16 v[44:47], v[120:123], v[232:235], v[44:47]
    ds_read_b64 v[244:245], v4 offset:1984
    ds_read_b64 v[246:247], v4 offset:1992
    v_mfma_f32_16x16x32_bf16 v[44:47], v[88:91], v[236:239], v[44:47]
    s_waitcnt vmcnt(1)
    v_lshlrev_b32 v48, 16, v20
    v_and_b32 v49, 0xffff0000, v20
    v_lshlrev_b32 v50, 16, v21
    v_mfma_f32_16x16x32_bf16 v[40:43], v[224:227], v[152:155], v[40:43]
    v_and_b32 v51, 0xffff0000, v21
    v_lshlrev_b32 v52, 16, v22
    v_and_b32 v53, 0xffff0000, v22
    v_mfma_f32_16x16x32_bf16 v[44:47], v[224:227], v[184:187], v[44:47]
    v_lshlrev_b32 v54, 16, v23
    v_and_b32 v55, 0xffff0000, v23
    s_waitcnt lgkmcnt(2)
    v_mfma_f32_16x16x32_bf16 v[44:47], v[228:231], v[152:155], v[44:47]
    v_mfma_f32_16x16x32_bf16 v[40:43], v[92:95], v[248:251], v[40:43]
    v_mfma_f32_16x16x32_bf16 v[44:47], v[124:127], v[248:251], v[44:47]
    v_mfma_f32_16x16x32_bf16 v[44:47], v[92:95], v[252:255], v[44:47]
    v_mfma_f32_16x16x32_bf16 v[40:43], v[240:243], v[156:159], v[40:43]
    v_mfma_f32_16x16x32_bf16 v[44:47], v[240:243], v[188:191], v[44:47]
    s_waitcnt lgkmcnt(0)
    v_mfma_f32_16x16x32_bf16 v[44:47], v[244:247], v[156:159], v[44:47]
    s_nop 4
    v_cvt_pk_bf16_f32 v40, v40, v41
    v_cvt_pk_bf16_f32 v41, v42, v43
    ds_write_b64 v12, v[40:41] offset:12544
    ds_write_b32 v1, v12 offset:64
    v_cvt_pk_bf16_f32 v44, v44, v45
    v_cvt_pk_bf16_f32 v45, v46, v47
    ds_write_b64 v12, v[44:45] offset:18816
    ds_write_b32 v1, v12 offset:96
    ds_read_b32 v3, v2 offset:64
    s_waitcnt lgkmcnt(0)
    v_cmp_eq_u32 vcc, 0, v3
    s_cbranch_vccz L_ok_h_1
L_retry_h_1:
    ds_read_b32 v3, v2 offset:64
    s_waitcnt lgkmcnt(0)
    v_cmp_eq_u32 vcc, 0, v3
    s_nop 1
    s_cbranch_vccnz L_retry_h_1
L_ok_h_1:
    ds_read_b64_tr_b16 v[44:45], v13 offset:12544
    ds_read_b64_tr_b16 v[46:47], v13 offset:15680
    s_waitcnt lgkmcnt(0)
    v_lshlrev_b32 v56, 16, v44
    v_and_b32 v57, 0xffff0000, v44
    v_lshlrev_b32 v58, 16, v45
    v_and_b32 v59, 0xffff0000, v45
    v_lshlrev_b32 v60, 16, v46
    v_and_b32 v61, 0xffff0000, v46
    v_lshlrev_b32 v62, 16, v47
    v_and_b32 v63, 0xffff0000, v47
    v_mul_f32 v56, v56, v48
    v_mul_f32 v57, v57, v49
    v_mul_f32 v58, v58, v50
    v_mul_f32 v59, v59, v51
    v_mul_f32 v60, v60, v52
    v_mul_f32 v61, v61, v53
    v_mul_f32 v62, v62, v54
    v_mul_f32 v63, v63, v55
    v_cvt_pk_bf16_f32 v20, v56, v57
    v_cvt_pk_bf16_f32 v21, v58, v59
    v_cvt_pk_bf16_f32 v22, v60, v61
    v_cvt_pk_bf16_f32 v23, v62, v63
    buffer_store_dwordx4 v[20:23], v14, s[36:39], s34 offen
    s_endpgm
.p2align 6
L_k2b:
    s_waitcnt vmcnt(0) lgkmcnt(0)
    s_barrier
    s_cmp_lg_u32 s28, 0
    s_cbranch_scc1 L_pub_1
    v_mov_b32 v1, s63
    s_mov_b64 exec, 1
    buffer_store_dword v1, off, s[56:59], s60 sc1
    s_mov_b64 exec, -1
L_pub_1:
    s_cmp_ge_u32 s3, 36
    s_cbranch_scc1 L_exit_b
    s_cmp_lt_u32 s28, 4
    s_cbranch_scc1 L_k2b_comp
    v_lshlrev_b32 v3, 4, v2
    s_mul_i32 s29, s3, 73728
    s_sub_u32 s30, s28, 4
    s_mul_i32 s30, s30, 4608
    s_add_u32 s29, s29, s30
    s_waitcnt lgkmcnt(0)
    s_add_u32 s12, s12, 2359296
    s_addc_u32 s13, s13, 0
    s_mov_b32 s16, s12
    s_and_b32 s17, s13, 0xffff
    s_mov_b32 s18, 2654208
    s_mov_b32 s19, 0x20000
    s_cmp_lg_u32 s28, 4
    s_cbranch_scc1 L_b_nopoll
    v_lshlrev_b32 v18, 7, v2
    s_movk_i32 s60, 20480
    s_mov_b32 s62, 200000
    s_add_u32 s61, s60, 8192
L_poll_2:
    buffer_load_dword v16, v18, s[56:59], s60 offen sc1
    buffer_load_dword v17, v18, s[56:59], s61 offen sc1
    s_waitcnt vmcnt(0)
    v_cmp_ne_u32 vcc, s63, v16
    v_cmp_ne_u32 s[54:55], s63, v17
    s_nop 1
    s_or_b64 vcc, vcc, s[54:55]
    s_nop 1
    s_cbranch_vccz L_polled_2
    s_sub_u32 s62, s62, 1
    s_cbranch_scc1 L_polled_2
    s_sleep 1
    s_branch L_poll_2
L_polled_2:
L_b_nopoll:
    s_barrier
    s_add_u32 m0, s30, 0
    s_add_u32 s31, s29, 0
    buffer_load_dwordx4 v3, s[16:19], s31 offen offset:0 sc1 lds
    buffer_load_dwordx4 v3, s[16:19], s31 offen offset:1024 sc1 lds
    buffer_load_dwordx4 v3, s[16:19], s31 offen offset:2048 sc1 lds
    buffer_load_dwordx4 v3, s[16:19], s31 offen offset:3072 sc1 lds
    s_add_u32 m0, s30, 4096
    s_add_u32 s31, s29, 4096
    s_mov_b32 exec_hi, 0
    buffer_load_dwordx4 v3, s[16:19], s31 offen sc1 lds
    s_mov_b32 exec_hi, -1
    s_add_u32 m0, s30, 18432
    s_add_u32 s31, s29, 18432
    buffer_load_dwordx4 v3, s[16:19], s31 offen offset:0 sc1 lds
    buffer_load_dwordx4 v3, s[16:19], s31 offen offset:1024 sc1 lds
    buffer_load_dwordx4 v3, s[16:19], s31 offen offset:2048 sc1 lds
    buffer_load_dwordx4 v3, s[16:19], s31 offen offset:3072 sc1 lds
    s_add_u32 m0, s30, 22528
    s_add_u32 s31, s29, 22528
    s_mov_b32 exec_hi, 0
    buffer_load_dwordx4 v3, s[16:19], s31 offen sc1 lds
    s_mov_b32 exec_hi, -1
    s_add_u32 m0, s30, 36864
    s_add_u32 s31, s29, 36864
    buffer_load_dwordx4 v3, s[16:19], s31 offen offset:0 sc1 lds
    buffer_load_dwordx4 v3, s[16:19], s31 offen offset:1024 sc1 lds
    buffer_load_dwordx4 v3, s[16:19], s31 offen offset:2048 sc1 lds
    buffer_load_dwordx4 v3, s[16:19], s31 offen offset:3072 sc1 lds
    s_add_u32 m0, s30, 40960
    s_add_u32 s31, s29, 40960
    s_mov_b32 exec_hi, 0
    buffer_load_dwordx4 v3, s[16:19], s31 offen sc1 lds
    s_mov_b32 exec_hi, -1
    s_add_u32 m0, s30, 55296
    s_add_u32 s31, s29, 55296
    buffer_load_dwordx4 v3, s[16:19], s31 offen offset:0 sc1 lds
    buffer_load_dwordx4 v3, s[16:19], s31 offen offset:1024 sc1 lds
    buffer_load_dwordx4 v3, s[16:19], s31 offen offset:2048 sc1 lds
    buffer_load_dwordx4 v3, s[16:19], s31 offen offset:3072 sc1 lds
    s_add_u32 m0, s30, 59392
    s_add_u32 s31, s29, 59392
    s_mov_b32 exec_hi, 0
    buffer_load_dwordx4 v3, s[16:19], s31 offen sc1 lds
    s_mov_b32 exec_hi, -1
    s_waitcnt vmcnt(15)
    s_barrier
    s_waitcnt vmcnt(10)
    s_barrier
    s_waitcnt vmcnt(5)
    s_barrier
    s_waitcnt vmcnt(0)
    s_barrier
    s_cmp_lg_u32 s28, 4
    s_cbranch_scc1 L_exit
    s_cmp_lg_u32 s3, 0
    s_cbranch_scc1 L_exit
    s_movk_i32 s60, 4096
    s_mov_b32 s62, 200000
    s_add_u32 s61, s60, 8192
L_poll_3:
    buffer_load_dword v16, v18, s[56:59], s60 offen sc1
    buffer_load_dword v17, v18, s[56:59], s61 offen sc1
    s_waitcnt vmcnt(0)
    v_cmp_ne_u32 vcc, s63, v16
    v_cmp_ne_u32 s[54:55], s63, v17
    s_nop 1
    s_or_b64 vcc, vcc, s[54:55]
    s_nop 1
    s_cbranch_vccz L_polled_3
    s_sub_u32 s62, s62, 1
    s_cbranch_scc1 L_polled_3
    s_sleep 1
    s_branch L_poll_3
L_polled_3:
    v_mov_b32 v1, s63
    v_mov_b32 v3, 0
    s_mov_b64 exec, 1
    buffer_store_dword v1, v3, s[56:59], 0 offen sc1
    s_endpgm
L_k2b_comp:
    v_and_b32 v4, 15, v2
    v_lshrrev_b32 v5, 4, v2
    v_bfe_u32 v8, v2, 2, 2
    v_lshl_add_u32 v6, v5, 3, v8
    v_mul_u32_u24 v6, 576, v6
    v_and_b32 v9, 3, v2
    v_lshl_add_u32 v6, v9, 4, v6
    v_and_b32 v10, 1, v5
    v_lshl_add_u32 v6, v10, 3, v6
    v_xor_b32 v7, 8, v6
    s_lshl_b32 s31, s28, 4
    v_add_u32 v10, s31, v4
    v_cvt_f32_u32 v10, v10
    v_add_f32 v10, 0.5, v10
    v_mul_f32 v10, 0x3c000000, v10
    v_lshlrev_b32 v11, 3, v5
    v_cvt_f32_u32 v11, v11
    v_mul_f32 v12, v11, v10
    v_add_f32 v13, v12, v10
    v_add_f32 v11, v10, v10
    v_cos_f32 v48, v12
    v_cos_f32 v49, v13
    v_sin_f32 v50, v12
    v_sin_f32 v51, v13
    v_add_f32 v12, v12, v11
    v_add_f32 v13, v13, v11
    v_cvt_pk_bf16_f32 v16, v48, v49
    v_cvt_pk_bf16_f32 v32, v50, v51
    v_cos_f32 v48, v12
    v_cos_f32 v49, v13
    v_sin_f32 v50, v12
    v_sin_f32 v51, v13
    v_add_f32 v12, v12, v11
    v_add_f32 v13, v13, v11
    v_cvt_pk_bf16_f32 v17, v48, v49
    v_cvt_pk_bf16_f32 v33, v50, v51
    v_cos_f32 v48, v12
    v_cos_f32 v49, v13
    v_sin_f32 v50, v12
    v_sin_f32 v51, v13
    v_add_f32 v12, v12, v11
    v_add_f32 v13, v13, v11
    v_cvt_pk_bf16_f32 v18, v48, v49
    v_cvt_pk_bf16_f32 v34, v50, v51
    v_cos_f32 v48, v12
    v_cos_f32 v49, v13
    v_sin_f32 v50, v12
    v_sin_f32 v51, v13
    v_fmamk_f32 v12, v10, 0x41d00000, v12
    v_fmamk_f32 v13, v10, 0x41d00000, v13
    v_cvt_pk_bf16_f32 v19, v48, v49
    v_cvt_pk_bf16_f32 v35, v50, v51
    v_cos_f32 v48, v12
    v_cos_f32 v49, v13
    v_sin_f32 v50, v12
    v_sin_f32 v51, v13
    v_add_f32 v12, v12, v11
    v_add_f32 v13, v13, v11
    v_cvt_pk_bf16_f32 v20, v48, v49
    v_cvt_pk_bf16_f32 v36, v50, v51
    v_cos_f32 v48, v12
    v_cos_f32 v49, v13
    v_sin_f32 v50, v12
    v_sin_f32 v51, v13
    v_add_f32 v12, v12, v11
    v_add_f32 v13, v13, v11
    v_cvt_pk_bf16_f32 v21, v48, v49
    v_cvt_pk_bf16_f32 v37, v50, v51
    v_cos_f32 v48, v12
    v_cos_f32 v49, v13
    v_sin_f32 v50, v12
    v_sin_f32 v51, v13
    v_add_f32 v12, v12, v11
    v_add_f32 v13, v13, v11
    v_cvt_pk_bf16_f32 v22, v48, v49
    v_cvt_pk_bf16_f32 v38, v50, v51
    v_cos_f32 v48, v12
    v_cos_f32 v49, v13
    v_sin_f32 v50, v12
    v_sin_f32 v51, v13
    v_fmamk_f32 v12, v10, 0x41d00000, v12
    v_fmamk_f32 v13, v10, 0x41d00000, v13
    v_cvt_pk_bf16_f32 v23, v48, v49
    v_cvt_pk_bf16_f32 v39, v50, v51
    v_cos_f32 v48, v12
    v_cos_f32 v49, v13
    v_sin_f32 v50, v12
    v_sin_f32 v51, v13
    v_add_f32 v12, v12, v11
    v_add_f32 v13, v13, v11
    v_cvt_pk_bf16_f32 v24, v48, v49
    v_cvt_pk_bf16_f32 v40, v50, v51
    v_cos_f32 v48, v12
    v_cos_f32 v49, v13
    v_sin_f32 v50, v12
    v_sin_f32 v51, v13
    v_add_f32 v12, v12, v11
    v_add_f32 v13, v13, v11
    v_cvt_pk_bf16_f32 v25, v48, v49
    v_cvt_pk_bf16_f32 v41, v50, v51
    v_cos_f32 v48, v12
    v_cos_f32 v49, v13
    v_sin_f32 v50, v12
    v_sin_f32 v51, v13
    v_add_f32 v12, v12, v11
    v_add_f32 v13, v13, v11
    v_cvt_pk_bf16_f32 v26, v48, v49
    v_cvt_pk_bf16_f32 v42, v50, v51
    v_cos_f32 v48, v12
    v_cos_f32 v49, v13
    v_sin_f32 v50, v12
    v_sin_f32 v51, v13
    v_fmamk_f32 v12, v10, 0x41d00000, v12
    v_fmamk_f32 v13, v10, 0x41d00000, v13
    v_cvt_pk_bf16_f32 v27, v48, v49
    v_cvt_pk_bf16_f32 v43, v50, v51
    v_cos_f32 v48, v12
    v_cos_f32 v49, v13
    v_sin_f32 v50, v12
    v_sin_f32 v51, v13
    v_add_f32 v12, v12, v11
    v_add_f32 v13, v13, v11
    v_cvt_pk_bf16_f32 v28, v48, v49
    v_cvt_pk_bf16_f32 v44, v50, v51
    v_cos_f32 v48, v12
    v_cos_f32 v49, v13
    v_sin_f32 v50, v12
    v_sin_f32 v51, v13
    v_add_f32 v12, v12, v11
    v_add_f32 v13, v13, v11
    v_cvt_pk_bf16_f32 v29, v48, v49
    v_cvt_pk_bf16_f32 v45, v50, v51
    v_cos_f32 v48, v12
    v_cos_f32 v49, v13
    v_sin_f32 v50, v12
    v_sin_f32 v51, v13
    v_add_f32 v12, v12, v11
    v_add_f32 v13, v13, v11
    v_cvt_pk_bf16_f32 v30, v48, v49
    v_cvt_pk_bf16_f32 v46, v50, v51
    v_cos_f32 v48, v12
    v_cos_f32 v49, v13
    v_sin_f32 v50, v12
    v_sin_f32 v51, v13
    v_cvt_pk_bf16_f32 v31, v48, v49
    v_cvt_pk_bf16_f32 v47, v50, v51
    s_waitcnt lgkmcnt(0)
    s_mov_b32 s20, s6
    s_and_b32 s21, s7, 0xffff
    s_mov_b32 s22, 4718592
    s_mov_b32 s23, 0x20000
    s_mul_i32 s33, s3, 57
    s_lshr_b32 s33, s33, 9
    s_mul_i32 s34, s33, 9
    s_sub_u32 s34, s3, s34
    s_lshl_b32 s35, s33, 2
    v_add_u32 v12, s35, v8
    s_lshl_b32 s35, s28, 8
    v_lshl_add_u32 v13, v5, 6, s35
    v_add_u32 v14, v12, v13
    v_sub_u32 v15, v12, v13
    v_add_u32 v15, 2032, v15
    s_lshl_b32 s35, s34, 6
    s_add_u32 s36, s35, 1152
    v_lshl_add_u32 v48, v9, 4, s36
    s_sub_u32 s36, 2288, s35
    v_lshlrev_b32 v49, 4, v9
    v_sub_u32 v49, s36, v49
    s_movk_i32 s37, 2304
    v_add_u32 v50, 0, v14
    v_mad_u32_u24 v52, v50, s37, v48
    v_sub_u32 v50, 2048, v50
    v_and_b32 v50, 2047, v50
    v_mad_u32_u24 v53, v50, s37, v49
    v_add_u32 v50, 0, v15
    v_mad_u32_u24 v54, v50, s37, v48
    v_sub_u32 v50, 2048, v50
    v_and_b32 v50, 2047, v50
    v_mad_u32_u24 v55, v50, s37, v49
    v_add_u32 v50, 16, v14
    v_mad_u32_u24 v56, v50, s37, v48
    v_sub_u32 v50, 2048, v50
    v_and_b32 v50, 2047, v50
    v_mad_u32_u24 v57, v50, s37, v49
    v_add_u32 v50, -16, v15
    v_mad_u32_u24 v58, v50, s37, v48
    v_sub_u32 v50, 2048, v50
    v_and_b32 v50, 2047, v50
    v_mad_u32_u24 v59, v50, s37, v49
    v_add_u32 v50, 32, v14
    v_mad_u32_u24 v60, v50, s37, v48
    v_sub_u32 v50, 2048, v50
    v_and_b32 v50, 2047, v50
    v_mad_u32_u24 v61, v50, s37, v49
    v_add_u32 v50, -32, v15
    v_mad_u32_u24 v62, v50, s37, v48
    v_sub_u32 v50, 2048, v50
    v_and_b32 v50, 2047, v50
    v_mad_u32_u24 v63, v50, s37, v49
    v_add_u32 v50, 48, v14
    v_mad_u32_u24 v64, v50, s37, v48
    v_sub_u32 v50, 2048, v50
    v_and_b32 v50, 2047, v50
    v_mad_u32_u24 v65, v50, s37, v49
    v_add_u32 v50, -48, v15
    v_mad_u32_u24 v66, v50, s37, v48
    v_sub_u32 v50, 2048, v50
    v_and_b32 v50, 2047, v50
    v_mad_u32_u24 v67, v50, s37, v49
    s_barrier
    s_barrier
    ds_read_b64_tr_b16 v[140:141], v6 offset:0
    ds_read_b64_tr_b16 v[142:143], v6 offset:2304
    ds_read_b64_tr_b16 v[144:145], v7 offset:0
    ds_read_b64_tr_b16 v[146:147], v7 offset:2304
    ds_read_b64_tr_b16 v[148:149], v6 offset:64
    ds_read_b64_tr_b16 v[150:151], v6 offset:2368
    ds_read_b64_tr_b16 v[152:153], v7 offset:64
    ds_read_b64_tr_b16 v[154:155], v7 offset:2368
    ds_read_b64_tr_b16 v[156:157], v6 offset:128
    ds_read_b64_tr_b16 v[158:159], v6 offset:2432
    ds_read_b64_tr_b16 v[160:161], v7 offset:128
    ds_read_b64_tr_b16 v[162:163], v7 offset:2432
    ds_read_b64_tr_b16 v[164:165], v6 offset:192
    ds_read_b64_tr_b16 v[166:167], v6 offset:2496
    s_waitcnt lgkmcnt(12)
    v_mfma_f32_16x16x32_bf16 v[68:71], v[16:19], v[140:143], 0
    ds_read_b64_tr_b16 v[168:169], v7 offset:192
    ds_read_b64_tr_b16 v[170:171], v7 offset:2496
    s_waitcnt lgkmcnt(12)
    v_mfma_f32_16x16x32_bf16 v[104:107], v[32:35], v[144:147], 0
    ds_read_b64_tr_b16 v[140:141], v6 offset:256
    ds_read_b64_tr_b16 v[142:143], v6 offset:2560
    s_waitcnt lgkmcnt(12)
    v_mfma_f32_16x16x32_bf16 v[72:75], v[16:19], v[148:151], 0
    ds_read_b64_tr_b16 v[144:145], v7 offset:256
    ds_read_b64_tr_b16 v[146:147], v7 offset:2560
    s_waitcnt lgkmcnt(12)
    v_mfma_f32_16x16x32_bf16 v[108:111], v[32:35], v[152:155], 0
    ds_read_b64_tr_b16 v[148:149], v6 offset:320
    ds_read_b64_tr_b16 v[150:151], v6 offset:2624
    s_waitcnt lgkmcnt(12)
    v_mfma_f32_16x16x32_bf16 v[76:79], v[16:19], v[156:159], 0
    ds_read_b64_tr_b16 v[152:153], v7 offset:320
    ds_read_b64_tr_b16 v[154:155], v7 offset:2624
    s_waitcnt lgkmcnt(12)
    v_mfma_f32_16x16x32_bf16 v[112:115], v[32:35], v[160:163], 0
    ds_read_b64_tr_b16 v[156:157], v6 offset:384
    ds_read_b64_tr_b16 v[158:159], v6 offset:2688
    s_waitcnt lgkmcnt(12)
    v_mfma_f32_16x16x32_bf16 v[80:83], v[16:19], v[164:167], 0
    ds_read_b64_tr_b16 v[160:161], v7 offset:384
    ds_read_b64_tr_b16 v[162:163], v7 offset:2688
    s_waitcnt lgkmcnt(12)
    v_mfma_f32_16x16x32_bf16 v[116:119], v[32:35], v[168:171], 0
    ds_read_b64_tr_b16 v[164:165], v6 offset:448
    ds_read_b64_tr_b16 v[166:167], v6 offset:2752
    s_waitcnt lgkmcnt(12)
    v_mfma_f32_16x16x32_bf16 v[84:87], v[16:19], v[140:143], 0
    ds_read_b64_tr_b16 v[168:169], v7 offset:448
    ds_read_b64_tr_b16 v[170:171], v7 offset:2752
    s_waitcnt lgkmcnt(12)
    v_mfma_f32_16x16x32_bf16 v[120:123], v[32:35], v[144:147], 0
    ds_read_b64_tr_b16 v[140:141], v6 offset:512
    ds_read_b64_tr_b16 v[142:143], v6 offset:2816
    s_waitcnt lgkmcnt(12)
    v_mfma_f32_16x16x32_bf16 v[88:91], v[16:19], v[148:151], 0
    ds_read_b64_tr_b16 v[144:145], v7 offset:512
    ds_read_b64_tr_b16 v[146:147], v7 offset:2816
    s_waitcnt lgkmcnt(12)
    v_mfma_f32_16x16x32_bf16 v[124:127], v[32:35], v[152:155], 0
    s_barrier
    ds_read_b64_tr_b16 v[148:149], v6 offset:18432
    ds_read_b64_tr_b16 v[150:151], v6 offset:20736
    s_waitcnt lgkmcnt(12)
    v_mfma_f32_16x16x32_bf16 v[92:95], v[16:19], v[156:159], 0
    ds_read_b64_tr_b16 v[152:153], v7 offset:18432
    ds_read_b64_tr_b16 v[154:155], v7 offset:20736
    s_waitcnt lgkmcnt(12)
    v_mfma_f32_16x16x32_bf16 v[128:131], v[32:35], v[160:163], 0
    ds_read_b64_tr_b16 v[156:157], v6 offset:18496
    ds_read_b64_tr_b16 v[158:159], v6 offset:20800
    s_waitcnt lgkmcnt(12)
    v_mfma_f32_16x16x32_bf16 v[96:99], v[16:19], v[164:167], 0
    ds_read_b64_tr_b16 v[160:161], v7 offset:18496
    ds_read_b64_tr_b16 v[162:163], v7 offset:20800
    s_waitcnt lgkmcnt(12)
    v_mfma_f32_16x16x32_bf16 v[132:135], v[32:35], v[168:171], 0
    ds_read_b64_tr_b16 v[164:165], v6 offset:18560
    ds_read_b64_tr_b16 v[166:167], v6 offset:20864
    s_waitcnt lgkmcnt(12)
    v_mfma_f32_16x16x32_bf16 v[100:103], v[16:19], v[140:143], 0
    ds_read_b64_tr_b16 v[168:169], v7 offset:18560
    ds_read_b64_tr_b16 v[170:171], v7 offset:20864
    s_waitcnt lgkmcnt(12)
    v_mfma_f32_16x16x32_bf16 v[136:139], v[32:35], v[144:147], 0
    ds_read_b64_tr_b16 v[140:141], v6 offset:18624
    ds_read_b64_tr_b16 v[142:143], v6 offset:20928
    s_waitcnt lgkmcnt(12)
    v_mfma_f32_16x16x32_bf16 v[68:71], v[20:23], v[148:151], v[68:71]
    ds_read_b64_tr_b16 v[144:145], v7 offset:18624
    ds_read_b64_tr_b16 v[146:147], v7 offset:20928
    s_waitcnt lgkmcnt(12)
    v_mfma_f32_16x16x32_bf16 v[104:107], v[36:39], v[152:155], v[104:107]
    ds_read_b64_tr_b16 v[148:149], v6 offset:18688
    ds_read_b64_tr_b16 v[150:151], v6 offset:20992
    s_waitcnt lgkmcnt(12)
    v_mfma_f32_16x16x32_bf16 v[72:75], v[20:23], v[156:159], v[72:75]
    ds_read_b64_tr_b16 v[152:153], v7 offset:18688
    ds_read_b64_tr_b16 v[154:155], v7 offset:20992
    s_waitcnt lgkmcnt(12)
    v_mfma_f32_16x16x32_bf16 v[108:111], v[36:39], v[160:163], v[108:111]
    ds_read_b64_tr_b16 v[156:157], v6 offset:18752
    ds_read_b64_tr_b16 v[158:159], v6 offset:21056
    s_waitcnt lgkmcnt(12)
    v_mfma_f32_16x16x32_bf16 v[76:79], v[20:23], v[164:167], v[76:79]
    ds_read_b64_tr_b16 v[160:161], v7 offset:18752
    ds_read_b64_tr_b16 v[162:163], v7 offset:21056
    s_waitcnt lgkmcnt(12)
    v_mfma_f32_16x16x32_bf16 v[112:115], v[36:39], v[168:171], v[112:115]
    ds_read_b64_tr_b16 v[164:165], v6 offset:18816
    ds_read_b64_tr_b16 v[166:167], v6 offset:21120
    s_waitcnt lgkmcnt(12)
    v_mfma_f32_16x16x32_bf16 v[80:83], v[20:23], v[140:143], v[80:83]
    ds_read_b64_tr_b16 v[168:169], v7 offset:18816
    ds_read_b64_tr_b16 v[170:171], v7 offset:21120
    s_waitcnt lgkmcnt(12)
    v_mfma_f32_16x16x32_bf16 v[116:119], v[36:39], v[144:147], v[116:119]
    ds_read_b64_tr_b16 v[140:141], v6 offset:18880
    ds_read_b64_tr_b16 v[142:143], v6 offset:21184
    s_waitcnt lgkmcnt(12)
    v_mfma_f32_16x16x32_bf16 v[84:87], v[20:23], v[148:151], v[84:87]
    ds_read_b64_tr_b16 v[144:145], v7 offset:18880
    ds_read_b64_tr_b16 v[146:147], v7 offset:21184
    s_waitcnt lgkmcnt(12)
    v_mfma_f32_16x16x32_bf16 v[120:123], v[36:39], v[152:155], v[120:123]
    ds_read_b64_tr_b16 v[148:149], v6 offset:18944
    ds_read_b64_tr_b16 v[150:151], v6 offset:21248
    s_waitcnt lgkmcnt(12)
    v_mfma_f32_16x16x32_bf16 v[88:91], v[20:23], v[156:159], v[88:91]
    ds_read_b64_tr_b16 v[152:153], v7 offset:18944
    ds_read_b64_tr_b16 v[154:155], v7 offset:21248
    s_waitcnt lgkmcnt(12)
    v_mfma_f32_16x16x32_bf16 v[124:127], v[36:39], v[160:163], v[124:127]
    s_barrier
    ds_read_b64_tr_b16 v[156:157], v6 offset:36864
    ds_read_b64_tr_b16 v[158:159], v6 offset:39168
    s_waitcnt lgkmcnt(12)
    v_mfma_f32_16x16x32_bf16 v[92:95], v[20:23], v[164:167], v[92:95]
    ds_read_b64_tr_b16 v[160:161], v7 offset:36864
    ds_read_b64_tr_b16 v[162:163], v7 offset:39168
    s_waitcnt lgkmcnt(12)
    v_mfma_f32_16x16x32_bf16 v[128:131], v[36:39], v[168:171], v[128:131]
    ds_read_b64_tr_b16 v[164:165], v6 offset:36928
    ds_read_b64_tr_b16 v[166:167], v6 offset:39232
    s_waitcnt lgkmcnt(12)
    v_mfma_f32_16x16x32_bf16 v[96:99], v[20:23], v[140:143], v[96:99]
    ds_read_b64_tr_b16 v[168:169], v7 offset:36928
    ds_read_b64_tr_b16 v[170:171], v7 offset:39232
    s_waitcnt lgkmcnt(12)
    v_mfma_f32_16x16x32_bf16 v[132:135], v[36:39], v[144:147], v[132:135]
    ds_read_b64_tr_b16 v[140:141], v6 offset:36992
    ds_read_b64_tr_b16 v[142:143], v6 offset:39296
    s_waitcnt lgkmcnt(12)
    v_mfma_f32_16x16x32_bf16 v[100:103], v[20:23], v[148:151], v[100:103]
    ds_read_b64_tr_b16 v[144:145], v7 offset:36992
    ds_read_b64_tr_b16 v[146:147], v7 offset:39296
    s_waitcnt lgkmcnt(12)
    v_mfma_f32_16x16x32_bf16 v[136:139], v[36:39], v[152:155], v[136:139]
    ds_read_b64_tr_b16 v[148:149], v6 offset:37056
    ds_read_b64_tr_b16 v[150:151], v6 offset:39360
    s_waitcnt lgkmcnt(12)
    v_mfma_f32_16x16x32_bf16 v[68:71], v[24:27], v[156:159], v[68:71]
    ds_read_b64_tr_b16 v[152:153], v7 offset:37056
    ds_read_b64_tr_b16 v[154:155], v7 offset:39360
    s_waitcnt lgkmcnt(12)
    v_mfma_f32_16x16x32_bf16 v[104:107], v[40:43], v[160:163], v[104:107]
    ds_read_b64_tr_b16 v[156:157], v6 offset:37120
    ds_read_b64_tr_b16 v[158:159], v6 offset:39424
    s_waitcnt lgkmcnt(12)
    v_mfma_f32_16x16x32_bf16 v[72:75], v[24:27], v[164:167], v[72:75]
    ds_read_b64_tr_b16 v[160:161], v7 offset:37120
    ds_read_b64_tr_b16 v[162:163], v7 offset:39424
    s_waitcnt lgkmcnt(12)
    v_mfma_f32_16x16x32_bf16 v[108:111], v[40:43], v[168:171], v[108:111]
    ds_read_b64_tr_b16 v[164:165], v6 offset:37184
    ds_read_b64_tr_b16 v[166:167], v6 offset:39488
    s_waitcnt lgkmcnt(12)
    v_mfma_f32_16x16x32_bf16 v[76:79], v[24:27], v[140:143], v[76:79]
    ds_read_b64_tr_b16 v[168:169], v7 offset:37184
    ds_read_b64_tr_b16 v[170:171], v7 offset:39488
    s_waitcnt lgkmcnt(12)
    v_mfma_f32_16x16x32_bf16 v[112:115], v[40:43], v[144:147], v[112:115]
    ds_read_b64_tr_b16 v[140:141], v6 offset:37248
    ds_read_b64_tr_b16 v[142:143], v6 offset:39552
    s_waitcnt lgkmcnt(12)
    v_mfma_f32_16x16x32_bf16 v[80:83], v[24:27], v[148:151], v[80:83]
    ds_read_b64_tr_b16 v[144:145], v7 offset:37248
    ds_read_b64_tr_b16 v[146:147], v7 offset:39552
    s_waitcnt lgkmcnt(12)
    v_mfma_f32_16x16x32_bf16 v[116:119], v[40:43], v[152:155], v[116:119]
    ds_read_b64_tr_b16 v[148:149], v6 offset:37312
    ds_read_b64_tr_b16 v[150:151], v6 offset:39616
    s_waitcnt lgkmcnt(12)
    v_mfma_f32_16x16x32_bf16 v[84:87], v[24:27], v[156:159], v[84:87]
    ds_read_b64_tr_b16 v[152:153], v7 offset:37312
    ds_read_b64_tr_b16 v[154:155], v7 offset:39616
    s_waitcnt lgkmcnt(12)
    v_mfma_f32_16x16x32_bf16 v[120:123], v[40:43], v[160:163], v[120:123]
    ds_read_b64_tr_b16 v[156:157], v6 offset:37376
    ds_read_b64_tr_b16 v[158:159], v6 offset:39680
    s_waitcnt lgkmcnt(12)
    v_mfma_f32_16x16x32_bf16 v[88:91], v[24:27], v[164:167], v[88:91]
    ds_read_b64_tr_b16 v[160:161], v7 offset:37376
    ds_read_b64_tr_b16 v[162:163], v7 offset:39680
    s_waitcnt lgkmcnt(12)
    v_mfma_f32_16x16x32_bf16 v[124:127], v[40:43], v[168:171], v[124:127]
    s_barrier
    ds_read_b64_tr_b16 v[164:165], v6 offset:55296
    ds_read_b64_tr_b16 v[166:167], v6 offset:57600
    s_waitcnt lgkmcnt(12)
    v_mfma_f32_16x16x32_bf16 v[92:95], v[24:27], v[140:143], v[92:95]
    ds_read_b64_tr_b16 v[168:169], v7 offset:55296
    ds_read_b64_tr_b16 v[170:171], v7 offset:57600
    s_waitcnt lgkmcnt(12)
    v_mfma_f32_16x16x32_bf16 v[128:131], v[40:43], v[144:147], v[128:131]
    ds_read_b64_tr_b16 v[140:141], v6 offset:55360
    ds_read_b64_tr_b16 v[142:143], v6 offset:57664
    s_waitcnt lgkmcnt(12)
    v_mfma_f32_16x16x32_bf16 v[96:99], v[24:27], v[148:151], v[96:99]
    ds_read_b64_tr_b16 v[144:145], v7 offset:55360
    ds_read_b64_tr_b16 v[146:147], v7 offset:57664
    s_waitcnt lgkmcnt(12)
    v_mfma_f32_16x16x32_bf16 v[132:135], v[40:43], v[152:155], v[132:135]
    ds_read_b64_tr_b16 v[148:149], v6 offset:55424
    ds_read_b64_tr_b16 v[150:151], v6 offset:57728
    s_waitcnt lgkmcnt(12)
    v_mfma_f32_16x16x32_bf16 v[100:103], v[24:27], v[156:159], v[100:103]
    ds_read_b64_tr_b16 v[152:153], v7 offset:55424
    ds_read_b64_tr_b16 v[154:155], v7 offset:57728
    s_waitcnt lgkmcnt(12)
    v_mfma_f32_16x16x32_bf16 v[136:139], v[40:43], v[160:163], v[136:139]
    ds_read_b64_tr_b16 v[156:157], v6 offset:55488
    ds_read_b64_tr_b16 v[158:159], v6 offset:57792
    s_waitcnt lgkmcnt(12)
    v_mfma_f32_16x16x32_bf16 v[68:71], v[28:31], v[164:167], v[68:71]
    ds_read_b64_tr_b16 v[160:161], v7 offset:55488
    ds_read_b64_tr_b16 v[162:163], v7 offset:57792
    s_waitcnt lgkmcnt(12)
    v_mfma_f32_16x16x32_bf16 v[104:107], v[44:47], v[168:171], v[104:107]
    ds_read_b64_tr_b16 v[164:165], v6 offset:55552
    ds_read_b64_tr_b16 v[166:167], v6 offset:57856
    s_waitcnt lgkmcnt(12)
    v_mfma_f32_16x16x32_bf16 v[72:75], v[28:31], v[140:143], v[72:75]
    ds_read_b64_tr_b16 v[168:169], v7 offset:55552
    ds_read_b64_tr_b16 v[170:171], v7 offset:57856
    s_waitcnt lgkmcnt(12)
    v_mfma_f32_16x16x32_bf16 v[108:111], v[44:47], v[144:147], v[108:111]
    ds_read_b64_tr_b16 v[140:141], v6 offset:55616
    ds_read_b64_tr_b16 v[142:143], v6 offset:57920
    s_waitcnt lgkmcnt(12)
    v_mfma_f32_16x16x32_bf16 v[76:79], v[28:31], v[148:151], v[76:79]
    ds_read_b64_tr_b16 v[144:145], v7 offset:55616
    ds_read_b64_tr_b16 v[146:147], v7 offset:57920
    s_waitcnt lgkmcnt(12)
    v_mfma_f32_16x16x32_bf16 v[112:115], v[44:47], v[152:155], v[112:115]
    ds_read_b64_tr_b16 v[148:149], v6 offset:55680
    ds_read_b64_tr_b16 v[150:151], v6 offset:57984
    s_waitcnt lgkmcnt(12)
    v_mfma_f32_16x16x32_bf16 v[80:83], v[28:31], v[156:159], v[80:83]
    ds_read_b64_tr_b16 v[152:153], v7 offset:55680
    ds_read_b64_tr_b16 v[154:155], v7 offset:57984
    s_waitcnt lgkmcnt(12)
    v_mfma_f32_16x16x32_bf16 v[116:119], v[44:47], v[160:163], v[116:119]
    ds_read_b64_tr_b16 v[156:157], v6 offset:55744
    ds_read_b64_tr_b16 v[158:159], v6 offset:58048
    s_waitcnt lgkmcnt(12)
    v_mfma_f32_16x16x32_bf16 v[84:87], v[28:31], v[164:167], v[84:87]
    ds_read_b64_tr_b16 v[160:161], v7 offset:55744
    ds_read_b64_tr_b16 v[162:163], v7 offset:58048
    s_waitcnt lgkmcnt(12)
    v_mfma_f32_16x16x32_bf16 v[120:123], v[44:47], v[168:171], v[120:123]
    ds_read_b64_tr_b16 v[164:165], v6 offset:55808
    ds_read_b64_tr_b16 v[166:167], v6 offset:58112
    s_waitcnt lgkmcnt(12)
    v_mfma_f32_16x16x32_bf16 v[88:91], v[28:31], v[140:143], v[88:91]
    ds_read_b64_tr_b16 v[168:169], v7 offset:55808
    ds_read_b64_tr_b16 v[170:171], v7 offset:58112
    s_waitcnt lgkmcnt(12)
    v_mfma_f32_16x16x32_bf16 v[124:127], v[44:47], v[144:147], v[124:127]
    s_waitcnt lgkmcnt(10)
    v_mfma_f32_16x16x32_bf16 v[92:95], v[28:31], v[148:151], v[92:95]
    s_waitcnt lgkmcnt(8)
    v_mfma_f32_16x16x32_bf16 v[128:131], v[44:47], v[152:155], v[128:131]
    s_waitcnt lgkmcnt(6)
    v_mfma_f32_16x16x32_bf16 v[96:99], v[28:31], v[156:159], v[96:99]
    s_waitcnt lgkmcnt(4)
    v_mfma_f32_16x16x32_bf16 v[132:135], v[44:47], v[160:163], v[132:135]
    s_waitcnt lgkmcnt(2)
    v_mfma_f32_16x16x32_bf16 v[100:103], v[28:31], v[164:167], v[100:103]
    s_waitcnt lgkmcnt(0)
    v_mfma_f32_16x16x32_bf16 v[136:139], v[44:47], v[168:171], v[136:139]
    v_add_f32 v172, v68, v104
    v_add_f32 v173, v72, v108
    v_add_f32 v174, v76, v112
    v_add_f32 v175, v80, v116
    v_add_f32 v176, v84, v120
    v_add_f32 v177, v88, v124
    v_add_f32 v178, v92, v128
    v_add_f32 v179, v96, v132
    v_add_f32 v180, v100, v136
    v_cvt_pk_bf16_f32 v192, v172, v173
    v_cvt_pk_bf16_f32 v193, v174, v175
    v_cvt_pk_bf16_f32 v194, v176, v177
    v_cvt_pk_bf16_f32 v195, v178, v179
    buffer_store_dwordx4 v[192:195], v52, s[20:23], 0 offen
    v_cvt_pk_bf16_f32 v196, v180, v179
    v_cvt_pk_bf16_f32 v197, v178, v177
    v_cvt_pk_bf16_f32 v198, v176, v175
    v_cvt_pk_bf16_f32 v199, v174, v173
    buffer_store_dwordx4 v[196:199], v53, s[20:23], 0 offen
    v_sub_f32 v182, v68, v104
    v_sub_f32 v183, v72, v108
    v_sub_f32 v184, v76, v112
    v_sub_f32 v185, v80, v116
    v_sub_f32 v186, v84, v120
    v_sub_f32 v187, v88, v124
    v_sub_f32 v188, v92, v128
    v_sub_f32 v189, v96, v132
    v_sub_f32 v190, v100, v136
    v_cvt_pk_bf16_f32 v200, v182, v183
    v_cvt_pk_bf16_f32 v201, v184, v185
    v_cvt_pk_bf16_f32 v202, v186, v187
    v_cvt_pk_bf16_f32 v203, v188, v189
    buffer_store_dwordx4 v[200:203], v54, s[20:23], 0 offen
    v_cvt_pk_bf16_f32 v204, v190, v189
    v_cvt_pk_bf16_f32 v205, v188, v187
    v_cvt_pk_bf16_f32 v206, v186, v185
    v_cvt_pk_bf16_f32 v207, v184, v183
    buffer_store_dwordx4 v[204:207], v55, s[20:23], 0 offen
    v_add_f32 v172, v69, v105
    v_add_f32 v173, v73, v109
    v_add_f32 v174, v77, v113
    v_add_f32 v175, v81, v117
    v_add_f32 v176, v85, v121
    v_add_f32 v177, v89, v125
    v_add_f32 v178, v93, v129
    v_add_f32 v179, v97, v133
    v_add_f32 v180, v101, v137
    v_cvt_pk_bf16_f32 v208, v172, v173
    v_cvt_pk_bf16_f32 v209, v174, v175
    v_cvt_pk_bf16_f32 v210, v176, v177
    v_cvt_pk_bf16_f32 v211, v178, v179
    buffer_store_dwordx4 v[208:211], v56, s[20:23], 0 offen
    v_cvt_pk_bf16_f32 v212, v180, v179
    v_cvt_pk_bf16_f32 v213, v178, v177
    v_cvt_pk_bf16_f32 v214, v176, v175
    v_cvt_pk_bf16_f32 v215, v174, v173
    buffer_store_dwordx4 v[212:215], v57, s[20:23], 0 offen
    v_sub_f32 v182, v69, v105
    v_sub_f32 v183, v73, v109
    v_sub_f32 v184, v77, v113
    v_sub_f32 v185, v81, v117
    v_sub_f32 v186, v85, v121
    v_sub_f32 v187, v89, v125
    v_sub_f32 v188, v93, v129
    v_sub_f32 v189, v97, v133
    v_sub_f32 v190, v101, v137
    v_cvt_pk_bf16_f32 v216, v182, v183
    v_cvt_pk_bf16_f32 v217, v184, v185
    v_cvt_pk_bf16_f32 v218, v186, v187
    v_cvt_pk_bf16_f32 v219, v188, v189
    buffer_store_dwordx4 v[216:219], v58, s[20:23], 0 offen
    v_cvt_pk_bf16_f32 v220, v190, v189
    v_cvt_pk_bf16_f32 v221, v188, v187
    v_cvt_pk_bf16_f32 v222, v186, v185
    v_cvt_pk_bf16_f32 v223, v184, v183
    buffer_store_dwordx4 v[220:223], v59, s[20:23], 0 offen
    v_add_f32 v172, v70, v106
    v_add_f32 v173, v74, v110
    v_add_f32 v174, v78, v114
    v_add_f32 v175, v82, v118
    v_add_f32 v176, v86, v122
    v_add_f32 v177, v90, v126
    v_add_f32 v178, v94, v130
    v_add_f32 v179, v98, v134
    v_add_f32 v180, v102, v138
    v_cvt_pk_bf16_f32 v192, v172, v173
    v_cvt_pk_bf16_f32 v193, v174, v175
    v_cvt_pk_bf16_f32 v194, v176, v177
    v_cvt_pk_bf16_f32 v195, v178, v179
    buffer_store_dwordx4 v[192:195], v60, s[20:23], 0 offen
    v_cvt_pk_bf16_f32 v196, v180, v179
    v_cvt_pk_bf16_f32 v197, v178, v177
    v_cvt_pk_bf16_f32 v198, v176, v175
    v_cvt_pk_bf16_f32 v199, v174, v173
    buffer_store_dwordx4 v[196:199], v61, s[20:23], 0 offen
    v_sub_f32 v182, v70, v106
    v_sub_f32 v183, v74, v110
    v_sub_f32 v184, v78, v114
    v_sub_f32 v185, v82, v118
    v_sub_f32 v186, v86, v122
    v_sub_f32 v187, v90, v126
    v_sub_f32 v188, v94, v130
    v_sub_f32 v189, v98, v134
    v_sub_f32 v190, v102, v138
    v_cvt_pk_bf16_f32 v200, v182, v183
    v_cvt_pk_bf16_f32 v201, v184, v185
    v_cvt_pk_bf16_f32 v202, v186, v187
    v_cvt_pk_bf16_f32 v203, v188, v189
    buffer_store_dwordx4 v[200:203], v62, s[20:23], 0 offen
    v_cvt_pk_bf16_f32 v204, v190, v189
    v_cvt_pk_bf16_f32 v205, v188, v187
    v_cvt_pk_bf16_f32 v206, v186, v185
    v_cvt_pk_bf16_f32 v207, v184, v183
    buffer_store_dwordx4 v[204:207], v63, s[20:23], 0 offen
    v_add_f32 v172, v71, v107
    v_add_f32 v173, v75, v111
    v_add_f32 v174, v79, v115
    v_add_f32 v175, v83, v119
    v_add_f32 v176, v87, v123
    v_add_f32 v177, v91, v127
    v_add_f32 v178, v95, v131
    v_add_f32 v179, v99, v135
    v_add_f32 v180, v103, v139
    v_cvt_pk_bf16_f32 v208, v172, v173
    v_cvt_pk_bf16_f32 v209, v174, v175
    v_cvt_pk_bf16_f32 v210, v176, v177
    v_cvt_pk_bf16_f32 v211, v178, v179
    buffer_store_dwordx4 v[208:211], v64, s[20:23], 0 offen
    v_cvt_pk_bf16_f32 v212, v180, v179
    v_cvt_pk_bf16_f32 v213, v178, v177
    v_cvt_pk_bf16_f32 v214, v176, v175
    v_cvt_pk_bf16_f32 v215, v174, v173
    buffer_store_dwordx4 v[212:215], v65, s[20:23], 0 offen
    v_sub_f32 v182, v71, v107
    v_sub_f32 v183, v75, v111
    v_sub_f32 v184, v79, v115
    v_sub_f32 v185, v83, v119
    v_sub_f32 v186, v87, v123
    v_sub_f32 v187, v91, v127
    v_sub_f32 v188, v95, v131
    v_sub_f32 v189, v99, v135
    v_sub_f32 v190, v103, v139
    v_cvt_pk_bf16_f32 v216, v182, v183
    v_cvt_pk_bf16_f32 v217, v184, v185
    v_cvt_pk_bf16_f32 v218, v186, v187
    v_cvt_pk_bf16_f32 v219, v188, v189
    buffer_store_dwordx4 v[216:219], v66, s[20:23], 0 offen
    v_cvt_pk_bf16_f32 v220, v190, v189
    v_cvt_pk_bf16_f32 v221, v188, v187
    v_cvt_pk_bf16_f32 v222, v186, v185
    v_cvt_pk_bf16_f32 v223, v184, v183
    buffer_store_dwordx4 v[220:223], v67, s[20:23], 0 offen
    s_endpgm
L_exit_b:
    s_endpgm
L_exit:
    s_endpgm
L_code_end:
.section .rodata,"a"
.p2align 6
.amdhsa_kernel concat_heads__ssm_conv_h3__spectral_fnet__prompt_kernel
  .amdhsa_next_free_vgpr 256
  .amdhsa_next_free_sgpr 64
  .amdhsa_accum_offset 256
  .amdhsa_group_segment_fixed_size 0
  .amdhsa_kernarg_size 112
  .amdhsa_user_sgpr_count 2
  .amdhsa_user_sgpr_kernarg_segment_ptr 1
  .amdhsa_system_sgpr_workgroup_id_x 1
.end_amdhsa_kernel
```
